```python
import torch

def _softmax(x, axis=-1):
    return torch.softmax(x, dim=axis)
def _gelu(x):
    return torch.nn.functional.gelu(x, approximate="tanh")
def _silu(x):
    return torch.nn.functional.silu(x)
def _sigmoid(x):
    return torch.sigmoid(x)
def _layernorm(x, axis=-1, eps=1e-5):
    m = x.mean(dim=axis, keepdim=True)
    v = x.var(dim=axis, keepdim=True, unbiased=False)
    return (x - m) / torch.sqrt(v + eps)
def _scatter_add(tgt, idx, src, axis=0):
    return tgt.clone().index_add_(axis, idx, src)
def _segment_sum(src, seg, n):
    out = torch.zeros((n,) + src.shape[1:], dtype=src.dtype)
    return out.index_add_(0, seg, src)
def _pad(x, pw):
    flat = tuple(v for pair in reversed(pw) for v in pair)
    return torch.nn.functional.pad(x, flat)

kernel_name = 'sequential_preLN__spectral_gfnet__dense_activation_silu__prompt'

def setup_inputs():

    _w = (lambda a: (lambda t: t.to(torch.bfloat16) if t.is_floating_point() else t)(torch.as_tensor(a)))
    def _A_setup():
        B, S, D = 1, 2048, 512
        Df = D // 2 + 1
        return {
            "x": _w((lambda *s: torch.randn(*s, dtype=torch.bfloat16) * 0.05)(B, S, D)),
            "w_r": _w((lambda *s: torch.randn(*s, dtype=torch.bfloat16) * 0.4)(S, Df) * 0.02),
            "w_i": _w((lambda *s: torch.randn(*s, dtype=torch.bfloat16) * 0.4)(S, Df) * 0.02),
        }
    _A_in = _A_setup()

    def _B_setup():
        B, S, D, F = 1, 2048, 512, 1376
        return {
            "x": _w((lambda *s: torch.randn(*s, dtype=torch.bfloat16) * 0.05)(B, S, D)),
            "w1": _w((lambda *s: torch.randn(*s, dtype=torch.bfloat16) * 0.8)(D, F) * (D ** -0.5)),
            "w2": _w((lambda *s: torch.randn(*s, dtype=torch.bfloat16) * 0.1)(F, D) * (F ** -0.5)),
        }
    _B_in = _B_setup()

    return {
        "A_x": _A_in["x"],
        "A_w_r": _A_in["w_r"],
        "A_w_i": _A_in["w_i"],
        "B_x": _B_in["x"],
        "B_w1": _B_in["w1"],
        "B_w2": _B_in["w2"],
    }

def reference(A_x, A_w_r, A_w_i, B_x, B_w1, B_w2):
    def _A_ref(x, w_r, w_i):
        B, S, D = x.shape
        X = (lambda x, axes=(-2,-1): torch.fft.rfft2(x.float(), dim=axes))(x, axes=(-2, -1))
        W = w_r + 1j * w_i
        X = X * W
        y = (lambda x, s, axes=(-2,-1): torch.fft.irfft2(x, s=s, dim=axes).to(torch.bfloat16))(X, (S, D), axes=(-2, -1))
        return y

    def _B_ref(x, w1, w2):
        h = torch.einsum("bsd,df->bsf", x, w1)
        h = _silu(h)
        out = torch.einsum("bsf,fd->bsd", h, w2)
        return out

    x = A_x
    h = x + _A_ref(_layernorm(x, axis=-1), A_w_r, A_w_i)
    h2 = h + _B_ref(_layernorm(h, axis=-1), B_w1, B_w2)
    return h2
```

```asm
; @launch grid=(256,1,1) block=(256,1,1) lds=163840
.amdgcn_target "amdgcn-amd-amdhsa--gfx950"
.text
.globl sequential_preLN__spectral_gfnet__dense_activation_silu__prompt_kernel
.p2align 8
.type sequential_preLN__spectral_gfnet__dense_activation_silu__prompt_kernel,@function
sequential_preLN__spectral_gfnet__dense_activation_silu__prompt_kernel:
    s_load_dwordx16 s[44:59], s[0:1], 0
    s_load_dwordx2 s[32:33], s[0:1], 64
    s_cmpk_ge_u32 s2, 256
    s_cbranch_scc1 L_end
    v_readfirstlane_b32 s4, v0
    s_lshr_b32 s37, s2, 3
    s_mov_b32 s43, 0x20000
    s_getpc_b64 s[40:41]
L_pc:
    s_movk_i32 s42, 20064
    s_lshl_b32 s38, s37, 7
    v_min_u32 v7, 5, v0
    v_lshlrev_b32 v7, 12, v7
    buffer_load_dword v222, v7, s[40:43], s38 offen
    v_and_b32 v5, 63, v0
    s_and_b32 s36, s2, 7
    s_lshl_b32 s38, s36, 8
    s_add_u32 s38, s38, s37
    s_add_u32 s38, s38, s4
    s_lshl_b32 s38, s38, 10
    s_lshl_b32 m0, s4, 6
    v_lshlrev_b32 v6, 4, v5
    s_lshl_b32 s10, s43, 4
    s_mov_b32 s11, s43
    s_lshl_b32 s36, s36, 5
    s_or_b32 s3, s36, s37
    s_lshr_b32 s4, s4, 6
    v_lshl_add_u32 v120, v5, 3, m0
    v_and_b32 v1, 15, v0
    v_bfe_u32 v2, v0, 4, 2
    s_mov_b32 s14, 1052672
    s_mov_b32 s22, 1409024
    s_mov_b32 s34, 9994240
    s_mov_b32 s18, s14
    s_mov_b32 s26, s22
    s_mov_b32 s30, s10
    s_mov_b32 s15, s43
    s_mov_b32 s19, s43
    s_mov_b32 s23, s43
    s_mov_b32 s27, s43
    s_mov_b32 s31, s43
    s_mov_b32 s35, s43
    v_cvt_f32_u32 v3, v1
    v_cvt_f32_u32 v4, v2
    s_mov_b64 s[60:61], 0xffff
    s_waitcnt lgkmcnt(0)
    s_mov_b64 s[8:9], s[44:45]
    buffer_load_dwordx4 v6, s[8:11], s38 offen lds
    s_addk_i32 s38, 31744
    buffer_load_dwordx4 v6, s[8:11], s38 offen offset:1024 lds
    s_load_dword s5, s[32:33], 0
    s_mov_b64 s[12:13], s[46:47]
    s_mov_b64 s[16:17], s[48:49]
    s_mov_b64 s[20:21], s[52:53]
    s_mov_b64 s[24:25], s[54:55]
    s_mov_b64 s[28:29], s[56:57]
    v_mul_f32 v5, v3, v4
    v_mul_f32 v6, 0x3e000000, v5
    v_mul_f32 v7, 0x3d000000, v3
    v_cos_f32 v104, v6
    v_sin_f32 v108, v6
    v_add_f32 v6, v6, v7
    v_cos_f32 v105, v6
    v_sin_f32 v109, v6
    v_add_f32 v6, v6, v7
    v_cos_f32 v106, v6
    v_sin_f32 v110, v6
    v_add_f32 v6, v6, v7
    v_cos_f32 v107, v6
    v_sin_f32 v111, v6
    v_and_b32 v6, 1, v1
    v_mul_u32_u24 v6, 0x8000, v6
    v_lshl_or_b32 v112, v6, 16, v6
    v_cvt_pk_bf16_f32 v148, v104, v105
    v_cvt_pk_bf16_f32 v156, v108, v109
    v_cvt_pk_bf16_f32 v164, -v108, -v109
    v_cvt_pk_bf16_f32 v152, v104, -v105
    v_cvt_pk_bf16_f32 v160, v108, -v109
    v_cvt_pk_bf16_f32 v168, -v108, v109
    v_cvt_pk_bf16_f32 v149, v106, v107
    v_cvt_pk_bf16_f32 v157, v110, v111
    v_cvt_pk_bf16_f32 v165, -v110, -v111
    v_cvt_pk_bf16_f32 v153, v106, -v107
    v_cvt_pk_bf16_f32 v161, v110, -v111
    v_cvt_pk_bf16_f32 v169, -v110, v111
    v_xor_b32 v150, v112, v148
    v_xor_b32 v158, v112, v156
    v_xor_b32 v166, v112, v164
    v_xor_b32 v154, v112, v152
    v_xor_b32 v162, v112, v160
    v_xor_b32 v170, v112, v168
    v_xor_b32 v151, v112, v149
    v_xor_b32 v159, v112, v157
    v_xor_b32 v167, v112, v165
    v_xor_b32 v155, v112, v153
    v_xor_b32 v163, v112, v161
    v_xor_b32 v171, v112, v169
    v_mov_b32 v7, 0xbf803f80
    v_cmp_eq_u32 vcc, 0, v1
    s_nop 1
    v_cndmask_b32 v28, v164, v7, vcc
    v_cndmask_b32 v29, v165, v7, vcc
    v_cndmask_b32 v30, v166, v7, vcc
    v_cndmask_b32 v31, v167, v7, vcc
    v_cndmask_b32 v126, 0, -1.0, vcc
    v_cvt_pk_bf16_f32 v196, v104, -v108
    v_cvt_pk_bf16_f32 v200, v104, -v108
    v_cvt_pk_bf16_f32 v197, v105, -v109
    v_cvt_pk_bf16_f32 v201, -v105, v109
    v_cvt_pk_bf16_f32 v198, v106, -v110
    v_cvt_pk_bf16_f32 v202, v106, -v110
    v_cvt_pk_bf16_f32 v199, v107, -v111
    v_cvt_pk_bf16_f32 v203, -v107, v111
    v_and_b32 v7, 0x80000000, v112
    v_or_b32 v7, 0x3f803f80, v7
    v_cndmask_b32 v196, v196, v7, s[60:61]
    v_cndmask_b32 v200, v200, v7, s[60:61]
    v_or_b32 v187, 0x3f00, v6
    s_lshr_b32 s37, s3, 6
    s_lshl_b32 s37, s37, 4
    s_and_b32 s38, s3, 15
    s_or_b32 s37, s37, s38
    s_bfe_u32 s38, s3, 0x20004
    s_lshl_b32 s38, s38, 8
    s_or_b32 s37, s37, s38
    s_mul_i32 s37, s37, 514
    v_bfe_u32 v6, v0, 3, 2
    v_bfe_u32 v7, v0, 5, 1
    v_lshl_or_b32 v6, v7, 4, v6
    v_mul_u32_u24 v6, 32896, v6
    s_and_b32 s40, s3, 1
    s_or_b32 s41, s40, s4
    s_cbranch_scc1 L_w256
    buffer_load_ushort v144, v6, s[12:15], s37 offen offset:512
    buffer_load_ushort v145, v6, s[16:19], s37 offen offset:512
L_w256:
    s_lshl_b32 s38, s4, 6
    s_add_u32 s38, s38, s40
    s_lshl_b32 s38, s38, 1
    s_add_u32 s37, s37, s38
    v_and_b32 v7, 7, v0
    v_lshl_add_u32 v6, v7, 4, v6
    s_lshl_b32 s39, s4, 12
    s_add_u32 m0, s39, 2048
    s_nop 0
    buffer_load_dwordx4 v6, s[12:15], s37 offen lds
    s_add_u32 m0, m0, 1024
    s_nop 0
    buffer_load_dwordx4 v6, s[16:19], s37 offen lds
    v_mul_f32 v5, v3, v4
    v_mul_f32 v6, 0x3c000000, v5
    v_mul_f32 v7, 0x3b000000, v3
    v_cos_f32 v32, v6
    v_sin_f32 v36, v6
    v_add_f32 v6, v6, v7
    v_cos_f32 v33, v6
    v_sin_f32 v37, v6
    v_add_f32 v6, v6, v7
    v_cos_f32 v34, v6
    v_sin_f32 v38, v6
    v_add_f32 v6, v6, v7
    v_cos_f32 v35, v6
    v_sin_f32 v39, v6
    v_mul_f32 v6, 0x3e800000, v5
    v_mul_f32 v7, 0x3d800000, v3
    v_cos_f32 v104, v6
    v_sin_f32 v108, v6
    v_add_f32 v6, v6, v7
    v_cos_f32 v105, v6
    v_sin_f32 v109, v6
    v_add_f32 v6, v6, v7
    v_cos_f32 v106, v6
    v_sin_f32 v110, v6
    v_add_f32 v6, v6, v7
    v_cos_f32 v107, v6
    v_sin_f32 v111, v6
    v_and_b32 v6, 8, v1
    v_mul_u32_u24 v6, 0x1000, v6
    v_lshl_or_b32 v6, v6, 16, v6
    v_cvt_pk_bf16_f32 v40, v104, v108
    v_cvt_pk_bf16_f32 v44, -v108, v104
    v_cvt_pk_bf16_f32 v41, v105, v109
    v_cvt_pk_bf16_f32 v45, -v109, v105
    v_cvt_pk_bf16_f32 v42, v106, v110
    v_cvt_pk_bf16_f32 v46, -v110, v106
    v_cvt_pk_bf16_f32 v43, v107, v111
    v_cvt_pk_bf16_f32 v47, -v111, v107
    v_lshlrev_b32 v114, 30, v2
    v_and_b32 v114, 0x80000000, v114
    v_xor_b32 v115, 0x80000000, v114
    v_xor_b32 v114, 0x8000, v114
    v_xor_b32 v172, v115, v40
    v_xor_b32 v176, v114, v44
    v_xor_b32 v44, v6, v44
    v_xor_b32 v173, v115, v41
    v_xor_b32 v177, v114, v45
    v_xor_b32 v45, v6, v45
    v_xor_b32 v174, v115, v42
    v_xor_b32 v178, v114, v46
    v_xor_b32 v46, v6, v46
    v_xor_b32 v175, v115, v43
    v_xor_b32 v179, v114, v47
    v_xor_b32 v47, v6, v47
    v_lshlrev_b32 v116, 1, v1
    v_cmp_eq_u32 vcc, 0, v1
    v_subrev_u32 v6, 15, v116
    s_nop 0
    v_cndmask_b32 v116, v116, 16, vcc
    v_cmp_gt_u32 vcc, 8, v1
    s_nop 1
    v_cndmask_b32 v116, v6, v116, vcc
    v_cvt_f32_u32 v116, v116
    v_mul_f32 v117, 0x3d000000, v116
    v_mul_f32 v6, 4.0, v117
    v_mul_f32 v6, v6, v4
    v_cos_f32 v104, v6
    v_sin_f32 v108, v6
    v_add_f32 v6, v6, v117
    v_cos_f32 v105, v6
    v_sin_f32 v109, v6
    v_add_f32 v6, v6, v117
    v_cos_f32 v106, v6
    v_sin_f32 v110, v6
    v_add_f32 v6, v6, v117
    v_cos_f32 v107, v6
    v_sin_f32 v111, v6
    v_and_b32 v6, 8, v1
    v_lshlrev_b32 v6, 1, v6
    v_cvt_pk_bf16_f32 v48, v104, 0
    v_cvt_pk_bf16_f32 v52, -v108, 0
    v_cvt_pk_bf16_f32 v49, v105, 0
    v_cvt_pk_bf16_f32 v53, -v109, 0
    v_cvt_pk_bf16_f32 v50, v106, 0
    v_cvt_pk_bf16_f32 v54, -v110, 0
    v_cvt_pk_bf16_f32 v51, v107, 0
    v_cvt_pk_bf16_f32 v55, -v111, 0
    v_lshlrev_b32 v48, v6, v48
    v_lshlrev_b32 v52, v6, v52
    v_lshlrev_b32 v49, v6, v49
    v_lshlrev_b32 v53, v6, v53
    v_lshlrev_b32 v50, v6, v50
    v_lshlrev_b32 v54, v6, v54
    v_lshlrev_b32 v51, v6, v51
    v_lshlrev_b32 v55, v6, v55
    s_lshl_b32 s59, s3, 2
    s_add_u32 s59, s59, s4
    s_mul_i32 s59, s59, 1408
    v_min_u32 v221, 10, v1
    v_lshlrev_b32 v221, 7, v221
    buffer_load_dword v222, v221, s[20:23], s59 offen
    s_lshl_b32 s59, s3, 2
    s_add_u32 s59, s59, s4
    s_mul_i32 s59, s59, 1408
    v_min_u32 v221, 10, v1
    v_lshlrev_b32 v221, 7, v221
    buffer_load_dword v222, v221, s[24:27], s59 offen
    v_bfe_u32 v5, v0, 2, 2
    v_lshlrev_b32 v5, 7, v5
    v_lshl_or_b32 v5, v2, 5, v5
    v_and_b32 v6, 3, v0
    v_lshl_or_b32 v5, v6, 3, v5
    s_lshl_b32 s39, s4, 12
    v_add_u32 v121, s39, v5
    v_mul_u32_u24 v6, 4416, v6
    v_bfe_u32 v5, v0, 2, 4
    v_lshl_add_u32 v5, v5, 4, v6
    s_mul_i32 s36, s4, 272
    v_add_u32 v124, s36, v5
    s_lshr_b32 s36, s4, 1
    s_mul_i32 s36, s36, 4416
    s_and_b32 s37, s4, 1
    s_lshl_b32 s37, s37, 2
    s_add_u32 s36, s36, s37
    s_add_u32 s36, s36, 16384
    v_mul_u32_u24 v5, 68, v2
    v_add_u32 v5, v5, v1
    v_lshl_add_u32 v122, v5, 4, s36
    v_bfe_u32 v5, v0, 5, 1
    v_mul_u32_u24 v5, 4416, v5
    v_bfe_u32 v6, v0, 3, 2
    v_lshl_add_u32 v146, v6, 1, v5
    v_mov_b32 v147, 0xbd000000
    v_add_u32 v5, s40, v0
    v_and_b32 v6, 31, v5
    v_lshrrev_b32 v5, 5, v5
    v_and_b32 v5, 7, v5
    v_mad_u32_u24 v7, v6, 17, v5
    v_sub_u32 v125, 559, v7
    v_cmp_gt_u32 vcc, 16, v6
    v_add_u32 v5, 8, v5
    s_nop 0
    v_cndmask_b32 v7, v125, v7, vcc
    v_cmp_eq_u32 vcc, 16, v6
    v_lshlrev_b32 v123, 4, v0
    s_nop 0
    v_cndmask_b32 v7, v7, v5, vcc
    v_lshlrev_b32 v125, 4, v7
    s_mul_i32 s48, s3, 16896
    s_add_u32 s48, s48, 262144
    s_add_u32 s49, s48, 4096
    s_add_u32 s50, s48, 8192
    s_add_u32 s51, s48, 12288
    v_and_b32 v5, 63, v0
    s_and_b32 s36, s3, 7
    s_mul_i32 s36, s36, 24
    s_sub_u32 s36, 172, s36
    v_bfrev_b32 v133, 2
    v_add_u32 v6, 0, v5
    v_mul_u32_u24 v7, 0xaab, v6
    v_lshrrev_b32 v7, 16, v7
    v_mul_u32_u24 v130, 24, v7
    v_sub_u32 v6, v6, v130
    v_and_b32 v130, 6, v7
    v_xor_b32 v6, v6, v130
    v_cmp_gt_u32 vcc, s36, v6
    v_mul_u32_u24 v7, 2752, v7
    v_lshl_add_u32 v6, v6, 4, v7
    v_subrev_u32 v6, 0, v6
    v_cndmask_b32 v130, v133, v6, vcc
    v_add_u32 v6, 64, v5
    v_mul_u32_u24 v7, 0xaab, v6
    v_lshrrev_b32 v7, 16, v7
    v_mul_u32_u24 v131, 24, v7
    v_sub_u32 v6, v6, v131
    v_and_b32 v131, 6, v7
    v_xor_b32 v6, v6, v131
    v_cmp_gt_u32 vcc, s36, v6
    v_mul_u32_u24 v7, 2752, v7
    v_lshl_add_u32 v6, v6, 4, v7
    v_subrev_u32 v6, 1024, v6
    v_cndmask_b32 v131, v133, v6, vcc
    v_add_u32 v6, 128, v5
    v_mul_u32_u24 v7, 0xaab, v6
    v_lshrrev_b32 v7, 16, v7
    v_mul_u32_u24 v132, 24, v7
    v_sub_u32 v6, v6, v132
    v_and_b32 v132, 6, v7
    v_xor_b32 v6, v6, v132
    v_cmp_gt_u32 vcc, s36, v6
    v_mul_u32_u24 v7, 2752, v7
    v_lshl_add_u32 v6, v6, 4, v7
    v_subrev_u32 v6, 2048, v6
    v_cndmask_b32 v132, v133, v6, vcc
    s_and_b32 s6, s3, 7
    s_mul_i32 s6, s6, 384
    s_lshr_b32 s36, s4, 1
    s_mul_i32 s36, s36, 704512
    s_add_u32 s6, s6, s36
    s_and_b32 s36, s4, 1
    s_mul_i32 s36, s36, 22016
    s_add_u32 s6, s6, s36
    s_waitcnt lgkmcnt(0)
    s_add_u32 s5, s5, 0x9e3779b1
    s_xor_b32 s46, s5, s4
    s_and_b32 s36, s46, 12
    s_lshl_b32 s36, s36, 27
    s_and_b32 s46, s46, 3
    s_lshl_b32 s46, s46, 13
    s_or_b32 s46, s46, s36
    s_xor_b32 s47, s46, 0x20000000
    s_bitcmp0_b32 s4, 0
    s_cselect_b32 s36, 0x60000000, 0
    s_or_b32 s46, s46, s36
    s_or_b32 s47, s47, s36
    v_mov_b32 v127, 0x60006000
    s_waitcnt vmcnt(4)
    ds_read_b64_tr_b16 v[8:9], v120 offset:0
    ds_read_b64_tr_b16 v[10:11], v120 offset:512
    ds_read_b64_tr_b16 v[12:13], v120 offset:1024
    ds_read_b64_tr_b16 v[14:15], v120 offset:1536
    s_waitcnt lgkmcnt(2)
    v_mfma_f32_16x16x32_bf16 v[72:75], v[8:11], v[148:151], 0
    v_mfma_f32_16x16x32_bf16 v[76:79], v[8:11], v[28:31], 0
    s_waitcnt lgkmcnt(0)
    v_mfma_f32_16x16x32_bf16 v[80:83], v[12:15], v[148:151], 0
    v_mfma_f32_16x16x32_bf16 v[84:87], v[12:15], v[28:31], 0
    v_lshlrev_b32 v56, 16, v8
    v_and_b32 v57, 0xffff0000, v8
    v_lshlrev_b32 v58, 16, v9
    v_and_b32 v59, 0xffff0000, v9
    v_lshlrev_b32 v60, 16, v10
    v_and_b32 v61, 0xffff0000, v10
    v_lshlrev_b32 v62, 16, v11
    v_and_b32 v63, 0xffff0000, v11
    v_lshlrev_b32 v64, 16, v12
    v_and_b32 v65, 0xffff0000, v12
    v_readlane_b32 s42, v72, 0
    v_lshlrev_b32 v66, 16, v13
    v_and_b32 v67, 0xffff0000, v13
    v_readlane_b32 s43, v80, 0
    v_lshlrev_b32 v68, 16, v14
    v_and_b32 v69, 0xffff0000, v14
    v_lshlrev_b32 v70, 16, v15
    v_and_b32 v71, 0xffff0000, v15
    v_mul_f32 v24, s42, v126
    v_mul_f32 v28, s42, v147
    v_mul_f32 v26, s43, v126
    v_mul_f32 v30, s43, v147
    v_pk_add_f32 v[72:73], v[72:73], v[24:25] op_sel_hi:[1,0]
    v_pk_add_f32 v[74:75], v[74:75], v[24:25] op_sel_hi:[1,0]
    v_pk_mul_f32 v[104:105], v[72:73], v[32:33]
    v_pk_mul_f32 v[106:107], v[76:77], v[32:33]
    v_pk_fma_f32 v[104:105], v[76:77], v[36:37], v[104:105]
    v_pk_fma_f32 v[106:107], v[72:73], v[36:37], v[106:107] neg_lo:[1,0,0] neg_hi:[1,0,0]
    v_pk_mul_f32 v[108:109], v[74:75], v[34:35]
    v_pk_mul_f32 v[110:111], v[78:79], v[34:35]
    v_pk_fma_f32 v[108:109], v[78:79], v[38:39], v[108:109]
    v_pk_fma_f32 v[110:111], v[74:75], v[38:39], v[110:111] neg_lo:[1,0,0] neg_hi:[1,0,0]
    v_cvt_pk_bf16_f32 v8, v104, v106
    v_cvt_pk_bf16_f32 v9, v105, v107
    v_cvt_pk_bf16_f32 v10, v108, v110
    v_cvt_pk_bf16_f32 v11, v109, v111
    v_pk_add_f32 v[80:81], v[80:81], v[26:27] op_sel_hi:[1,0]
    v_pk_add_f32 v[82:83], v[82:83], v[26:27] op_sel_hi:[1,0]
    v_pk_mul_f32 v[112:113], v[80:81], v[32:33]
    v_pk_mul_f32 v[114:115], v[84:85], v[32:33]
    v_pk_fma_f32 v[112:113], v[84:85], v[36:37], v[112:113]
    v_pk_fma_f32 v[114:115], v[80:81], v[36:37], v[114:115] neg_lo:[1,0,0] neg_hi:[1,0,0]
    v_pk_mul_f32 v[116:117], v[82:83], v[34:35]
    v_pk_mul_f32 v[118:119], v[86:87], v[34:35]
    v_pk_fma_f32 v[116:117], v[86:87], v[38:39], v[116:117]
    v_pk_fma_f32 v[118:119], v[82:83], v[38:39], v[118:119] neg_lo:[1,0,0] neg_hi:[1,0,0]
    v_cvt_pk_bf16_f32 v12, v112, v114
    v_cvt_pk_bf16_f32 v13, v113, v115
    v_cvt_pk_bf16_f32 v14, v116, v118
    v_cvt_pk_bf16_f32 v15, v117, v119
    v_mfma_f32_16x16x32_bf16 v[88:91], v[8:11], v[48:51], 0
    v_add_f32 v56, v56, v28
    v_add_f32 v57, v57, v28
    v_mfma_f32_16x16x32_bf16 v[92:95], v[8:11], v[52:55], 0
    v_add_f32 v58, v58, v28
    v_add_f32 v59, v59, v28
    v_mfma_f32_16x16x32_bf16 v[72:75], v[8:11], v[40:43], 0
    v_add_f32 v60, v60, v28
    v_add_f32 v61, v61, v28
    v_mfma_f32_16x16x32_bf16 v[76:79], v[8:11], v[44:47], 0
    v_add_f32 v62, v62, v28
    v_add_f32 v63, v63, v28
    v_mfma_f32_16x16x32_bf16 v[96:99], v[12:15], v[48:51], 0
    s_add_u32 s96, s6, 0
    s_mul_i32 s97, s4, 3072
    s_add_u32 m0, s97, 36864
    s_nop 0
    buffer_load_dwordx4 v130, s[20:23], s96 offen offset:0 lds
    v_add_f32 v64, v64, v30
    v_add_f32 v65, v65, v30
    v_mfma_f32_16x16x32_bf16 v[100:103], v[12:15], v[52:55], 0
    v_add_f32 v66, v66, v30
    v_add_f32 v67, v67, v30
    v_mfma_f32_16x16x32_bf16 v[80:83], v[12:15], v[40:43], 0
    buffer_load_dwordx4 v131, s[20:23], s96 offen offset:1024 lds
    v_add_f32 v68, v68, v30
    v_add_f32 v69, v69, v30
    v_mfma_f32_16x16x32_bf16 v[84:87], v[12:15], v[44:47], 0
    v_add_f32 v70, v70, v30
    v_add_f32 v71, v71, v30
    v_pk_mul_f32 v[104:105], v[56:57], v[56:57]
    v_pk_mul_f32 v[108:109], v[64:65], v[64:65]
    buffer_load_dwordx4 v132, s[20:23], s96 offen offset:2048 lds
    v_pk_fma_f32 v[104:105], v[58:59], v[58:59], v[104:105]
    v_pk_fma_f32 v[108:109], v[66:67], v[66:67], v[108:109]
    v_pk_fma_f32 v[104:105], v[60:61], v[60:61], v[104:105]
    v_pk_fma_f32 v[108:109], v[68:69], v[68:69], v[108:109]
    v_pk_fma_f32 v[104:105], v[62:63], v[62:63], v[104:105]
    v_pk_fma_f32 v[108:109], v[70:71], v[70:71], v[108:109]
    v_pk_add_f32 v[56:57], v[56:57], v[58:59]
    v_pk_add_f32 v[64:65], v[64:65], v[66:67]
    v_pk_add_f32 v[60:61], v[60:61], v[62:63]
    v_pk_add_f32 v[68:69], v[68:69], v[70:71]
    s_add_u32 m0, m0, 12288
    s_add_u32 s96, s96, 44032
    buffer_load_dwordx4 v130, s[20:23], s96 offen offset:0 lds
    v_pk_add_f32 v[56:57], v[56:57], v[60:61]
    v_pk_add_f32 v[64:65], v[64:65], v[68:69]
    v_add_f32 v112, v104, v105
    v_add_f32 v114, v56, v57
    v_add_f32 v113, v108, v109
    v_add_f32 v115, v64, v65
    s_mov_b32 s62, -1
    s_mov_b32 s63, 0
    v_permlane32_swap_b32 v112, v113
    v_permlane32_swap_b32 v114, v115
    buffer_load_dwordx4 v131, s[20:23], s96 offen offset:1024 lds
    v_add_f32 v112, v112, v113
    v_add_f32 v114, v114, v115
    v_cndmask_b32 v72, v72, v88, s[60:61]
    v_add_f32_dpp v112, v112, v112 quad_perm:[1,0,3,2] row_mask:0xf bank_mask:0xf
    v_add_f32_dpp v114, v114, v114 quad_perm:[1,0,3,2] row_mask:0xf bank_mask:0xf
    v_cndmask_b32 v76, v76, v92, s[60:61]
    v_add_f32_dpp v112, v112, v112 quad_perm:[2,3,0,1] row_mask:0xf bank_mask:0xf
    v_add_f32_dpp v114, v114, v114 quad_perm:[2,3,0,1] row_mask:0xf bank_mask:0xf
    v_cndmask_b32 v80, v80, v96, s[60:61]
    v_add_f32_dpp v112, v112, v112 row_ror:4 row_mask:0xf bank_mask:0xf
    buffer_load_dwordx4 v132, s[20:23], s96 offen offset:2048 lds
    v_add_f32_dpp v114, v114, v114 row_ror:4 row_mask:0xf bank_mask:0xf
    v_cndmask_b32 v84, v84, v100, s[60:61]
    v_add_f32_dpp v112, v112, v112 row_ror:8 row_mask:0xf bank_mask:0xf
    v_add_f32_dpp v114, v114, v114 row_ror:8 row_mask:0xf bank_mask:0xf
    v_mov_b32 v104, 0x3727c5ac
    v_add_f32_dpp v112, v112, v112 row_bcast:15 row_mask:0xa bank_mask:0xf
    v_add_f32_dpp v114, v114, v114 row_bcast:15 row_mask:0xa bank_mask:0xf
    v_cndmask_b32 v106, v30, v28, s[62:63]
    v_mul_f32 v114, 0x3b000000, v114
    v_mul_f32 v112, 0x3b000000, v112
    v_fma_f32 v112, -v114, v114, v112
    v_fmac_f32 v104, 0x3f800000, v112
    v_rsq_f32 v104, v104
    v_sub_f32 v114, v114, v106
    v_mul_f32 v104, 0x0e800000, v104
    v_readlane_b32 s42, v114, 31
    v_readlane_b32 s62, v104, 31
    v_readlane_b32 s63, v104, 63
    v_readlane_b32 s43, v114, 63
    s_nop 0
    v_pk_mul_f32 v[72:73], v[72:73], s[62:63] op_sel:[0,0] op_sel_hi:[1,0]
    v_pk_mul_f32 v[80:81], v[80:81], s[62:63] op_sel:[0,1] op_sel_hi:[1,1]
    v_cvt_pk_bf16_f32 v56, v72, v80
    v_cvt_pk_bf16_f32 v57, v73, v81
    v_bfi_b32 v56, v127, s46, v56
    v_bfi_b32 v57, v127, s46, v57
    ds_write_b32 v122, v56 offset:0
    ds_write_b32 v122, v57 offset:272
    v_pk_mul_f32 v[74:75], v[74:75], s[62:63] op_sel:[0,0] op_sel_hi:[1,0]
    v_pk_mul_f32 v[82:83], v[82:83], s[62:63] op_sel:[0,1] op_sel_hi:[1,1]
    v_cvt_pk_bf16_f32 v58, v74, v82
    v_cvt_pk_bf16_f32 v59, v75, v83
    v_bfi_b32 v58, v127, s46, v58
    v_bfi_b32 v59, v127, s46, v59
    ds_write_b32 v122, v58 offset:544
    ds_write_b32 v122, v59 offset:816
    s_waitcnt vmcnt(8)
    ds_read_b64_tr_b16 v[16:17], v121 offset:2048
    ds_read_b64_tr_b16 v[18:19], v121 offset:2560
    ds_read_b64_tr_b16 v[20:21], v121 offset:3072
    ds_read_b64_tr_b16 v[22:23], v121 offset:3584
    v_pk_mul_f32 v[76:77], v[76:77], s[62:63] op_sel:[0,0] op_sel_hi:[1,0]
    v_pk_mul_f32 v[84:85], v[84:85], s[62:63] op_sel:[0,1] op_sel_hi:[1,1]
    v_cvt_pk_bf16_f32 v60, v76, v84
    v_cvt_pk_bf16_f32 v61, v77, v85
    v_bfi_b32 v60, v127, s47, v60
    v_bfi_b32 v61, v127, s47, v61
    ds_write_b32 v122, v60 offset:8832
    ds_write_b32 v122, v61 offset:9104
    v_pk_mul_f32 v[78:79], v[78:79], s[62:63] op_sel:[0,0] op_sel_hi:[1,0]
    v_pk_mul_f32 v[86:87], v[86:87], s[62:63] op_sel:[0,1] op_sel_hi:[1,1]
    v_cvt_pk_bf16_f32 v62, v78, v86
    v_cvt_pk_bf16_f32 v63, v79, v87
    v_bfi_b32 v62, v127, s47, v62
    v_bfi_b32 v63, v127, s47, v63
    ds_write_b32 v122, v62 offset:9376
    ds_write_b32 v122, v63 offset:9648
    s_waitcnt lgkmcnt(4)
    ds_write_b64 v125, v[16:17] offset:16392
    ds_write_b64 v125, v[18:19] offset:20808
    ds_write_b64 v125, v[20:21] offset:25224
    ds_write_b64 v125, v[22:23] offset:29640
    s_cmp_lg_u32 s41, 0
    s_cbranch_scc1 L_w256b
    ds_write_b16 v146, v144 offset:16392
    ds_write_b16 v146, v145 offset:25224
L_w256b:
    s_waitcnt lgkmcnt(0)
    s_barrier
    ds_read_b128 v[72:75], v124 offset:16384
    ds_read_b128 v[76:79], v124 offset:17472
    ds_read_b128 v[80:83], v124 offset:18560
    ds_read_b128 v[84:87], v124 offset:19648
    s_waitcnt lgkmcnt(3)
    buffer_store_dwordx4 v[72:75], v123, s[32:35], s48 offen sc1
    s_waitcnt lgkmcnt(2)
    buffer_store_dwordx4 v[76:79], v123, s[32:35], s49 offen sc1
    s_waitcnt lgkmcnt(1)
    buffer_store_dwordx4 v[80:83], v123, s[32:35], s50 offen sc1
    s_waitcnt lgkmcnt(0)
    buffer_store_dwordx4 v[84:87], v123, s[32:35], s51 offen sc1
    v_lshrrev_b32 v5, 2, v0
    s_add_u32 m0, m0, 12288
    s_add_u32 s96, s96, 44032
    buffer_load_dwordx4 v130, s[20:23], s96 offen offset:0 lds
    v_and_b32 v6, 3, v0
    v_mul_u32_u24 v7, 16896, v5
    v_lshl_add_u32 v120, v6, 4, v7
    s_lshl_b32 s52, s3, 6
    s_add_u32 s52, s52, 262144
    s_add_u32 s53, s52, 1081344
    s_add_u32 s54, s52, 2162688
    s_add_u32 s55, s52, 3244032
    v_mul_f32 v7, 0x3d800000, v3
    v_fma_f32 v6, v4, 4.0, -4.0
    v_add_f32 v6, 0xc0600000, v6
    v_mul_f32 v6, v6, v7
    v_cos_f32 v104, v6
    v_sin_f32 v108, v6
    buffer_load_dwordx4 v131, s[20:23], s96 offen offset:1024 lds
    v_add_f32 v6, v6, v7
    v_cos_f32 v105, v6
    v_sin_f32 v109, v6
    v_add_f32 v6, v6, v7
    v_cos_f32 v106, v6
    v_sin_f32 v110, v6
    v_add_f32 v6, v6, v7
    v_cos_f32 v107, v6
    v_sin_f32 v111, v6
    v_cmp_gt_u32 vcc, 2, v2
    buffer_load_dwordx4 v132, s[20:23], s96 offen offset:2048 lds
    v_cvt_pk_bf16_f32 v104, v104, -v108
    v_cvt_pk_bf16_f32 v105, v105, -v109
    v_cvt_pk_bf16_f32 v106, v106, -v110
    v_cvt_pk_bf16_f32 v107, v107, -v111
    v_cndmask_b32 v180, 0, v172, vcc
    v_cndmask_b32 v184, v104, 0, vcc
    v_cndmask_b32 v181, 0, v173, vcc
    v_cndmask_b32 v185, v105, 0, vcc
    v_cndmask_b32 v182, 0, v174, vcc
    v_cndmask_b32 v180, v180, v187, s[60:61]
    v_cndmask_b32 v186, v106, 0, vcc
    v_cndmask_b32 v183, 0, v175, vcc
    v_cndmask_b32 v187, v107, 0, vcc
    v_mul_f32 v188, 0x67000000, v32
    v_mul_f32 v189, 0x67000000, v33
    v_mul_f32 v190, 0x67000000, v34
    s_add_u32 m0, m0, 12288
    s_add_u32 s96, s96, 44032
    buffer_load_dwordx4 v130, s[20:23], s96 offen offset:0 lds
    v_mul_f32 v191, 0x67000000, v35
    v_mul_f32 v192, 0x67000000, v36
    v_mul_f32 v193, 0x67000000, v37
    v_mul_f32 v194, 0x67000000, v38
    v_mul_f32 v195, 0x67000000, v39
    v_lshlrev_b32 v5, 5, v1
    v_lshl_or_b32 v5, v2, 3, v5
    s_lshl_b32 s36, s4, 12
    v_add_u32 v5, s36, v5
    ds_read_b64 v[204:205], v5 offset:0
    ds_read_b64 v[206:207], v5 offset:512
    ds_read_b64 v[208:209], v5 offset:1024
    ds_read_b64 v[210:211], v5 offset:1536
    v_bfe_u32 v5, v0, 1, 1
    v_and_b32 v6, 1, v0
    v_lshlrev_b32 v6, 3, v6
    buffer_load_dwordx4 v131, s[20:23], s96 offen offset:1024 lds
    v_bfe_u32 v7, v0, 2, 4
    v_lshl_or_b32 v7, v7, 4, v6
    s_and_b32 s36, s4, 1
    s_mul_i32 s36, s36, 4224
    s_lshr_b32 s37, s4, 1
    s_lshl_b32 s37, s37, 8
    s_add_u32 s36, s36, s37
    s_add_u32 s36, s36, 16384
    v_mul_u32_u24 v121, 2112, v5
    v_add3_u32 v121, v121, v7, s36
    s_lshl_b32 s36, s4, 8
    s_add_u32 s36, s36, 24832
    v_mul_u32_u24 v122, 4160, v5
    v_add3_u32 v122, v122, v7, s36
    v_and_b32 v5, 63, v0
    v_lshlrev_b32 v123, 4, v5
    buffer_load_dwordx4 v132, s[20:23], s96 offen offset:2048 lds
    v_lshlrev_b32 v124, 4, v0
    v_lshrrev_b32 v5, 1, v2
    v_and_b32 v6, 1, v2
    v_lshlrev_b32 v7, 4, v1
    v_lshl_or_b32 v7, v5, 8, v7
    v_lshl_or_b32 v7, v6, 3, v7
    s_lshl_b32 s36, s4, 9
    s_add_u32 s36, s36, 0
    v_add_u32 v125, s36, v7
    v_lshlrev_b32 v7, 5, v1
    v_lshl_or_b32 v7, v5, 10, v7
    v_lshl_or_b32 v126, v6, 4, v7
    s_mul_i32 s56, s3, 8448
    s_lshl_b32 s36, s4, 11
    s_add_u32 s56, s56, s36
    s_add_u32 s56, s56, 4587520
    v_and_b32 v5, 1, v1
    v_mul_u32_u24 v5, 0x8000, v5
    v_lshl_or_b32 v32, v5, 16, v5
    s_lshl_b32 s36, s4, 4
    v_cvt_f32_u32 v34, s36
    v_add_f32 v33, v34, v3
    v_mul_f32 v7, 0x3c800000, v33
    v_mul_f32 v5, v33, v4
    v_mul_f32 v6, 0x3e000000, v5
    v_cos_f32 v104, v6
    v_sin_f32 v112, v6
    v_add_f32 v6, v6, v7
    v_cos_f32 v105, v6
    v_sin_f32 v113, v6
    v_add_f32 v6, v6, v7
    v_cos_f32 v106, v6
    v_sin_f32 v114, v6
    v_add_f32 v6, v6, v7
    v_cos_f32 v107, v6
    v_sin_f32 v115, v6
    v_add_f32 v6, v6, v7
    v_cos_f32 v108, v6
    v_sin_f32 v116, v6
    v_add_f32 v6, v6, v7
    v_cos_f32 v109, v6
    v_sin_f32 v117, v6
    v_add_f32 v6, v6, v7
    v_cos_f32 v110, v6
    v_sin_f32 v118, v6
    v_add_f32 v6, v6, v7
    v_cos_f32 v111, v6
    v_sin_f32 v119, v6
    v_cvt_pk_bf16_f32 v8, v104, v105
    v_cvt_pk_bf16_f32 v16, v112, v113
    v_cvt_pk_bf16_f32 v24, -v112, -v113
    v_cvt_pk_bf16_f32 v9, v106, v107
    v_cvt_pk_bf16_f32 v17, v114, v115
    v_cvt_pk_bf16_f32 v25, -v114, -v115
    v_cvt_pk_bf16_f32 v10, v108, v109
    v_cvt_pk_bf16_f32 v18, v116, v117
    v_cvt_pk_bf16_f32 v26, -v116, -v117
    v_cvt_pk_bf16_f32 v11, v110, v111
    v_cvt_pk_bf16_f32 v19, v118, v119
    v_cvt_pk_bf16_f32 v27, -v118, -v119
    v_xor_b32 v12, v32, v8
    v_xor_b32 v20, v32, v16
    v_xor_b32 v28, v32, v24
    v_xor_b32 v13, v32, v9
    v_xor_b32 v21, v32, v17
    v_xor_b32 v29, v32, v25
    v_xor_b32 v14, v32, v10
    v_xor_b32 v22, v32, v18
    v_xor_b32 v30, v32, v26
    v_xor_b32 v15, v32, v11
    v_xor_b32 v23, v32, v19
    v_xor_b32 v31, v32, v27
    v_mul_f32 v7, 0x3a000000, v33
    v_mul_f32 v6, 0x3b000000, v5
    v_cos_f32 v56, v6
    v_sin_f32 v64, v6
    v_add_f32 v6, v6, v7
    v_cos_f32 v57, v6
    v_sin_f32 v65, v6
    v_add_f32 v6, v6, v7
    v_cos_f32 v58, v6
    v_sin_f32 v66, v6
    v_add_f32 v6, v6, v7
    v_cos_f32 v59, v6
    v_sin_f32 v67, v6
    v_fmac_f32 v6, 0x41500000, v7
    v_cos_f32 v60, v6
    v_sin_f32 v68, v6
    v_add_f32 v6, v6, v7
    v_cos_f32 v61, v6
    v_sin_f32 v69, v6
    v_add_f32 v6, v6, v7
    v_cos_f32 v62, v6
    v_sin_f32 v70, v6
    v_add_f32 v6, v6, v7
    v_cos_f32 v63, v6
    v_sin_f32 v71, v6
    v_fma_f32 v5, v4, 4.0, v34
    v_mul_f32 v7, 0x3a000000, v3
    v_mul_f32 v6, v5, v7
    v_cos_f32 v72, v6
    v_sin_f32 v80, v6
    v_add_f32 v6, v6, v7
    v_cos_f32 v73, v6
    v_sin_f32 v81, v6
    v_add_f32 v6, v6, v7
    v_cos_f32 v74, v6
    s_barrier
    buffer_load_dwordx4 v[88:91], v120, s[32:35], s52 offen sc1
    buffer_load_dwordx4 v[92:95], v120, s[32:35], s53 offen sc1
    buffer_load_dwordx4 v[96:99], v120, s[32:35], s54 offen sc1
    buffer_load_dwordx4 v[100:103], v120, s[32:35], s55 offen sc1
    v_sin_f32 v82, v6
    s_add_u32 m0, m0, 12288
    s_add_u32 s96, s96, 44032
    buffer_load_dwordx4 v130, s[20:23], s96 offen offset:0 lds
    v_add_f32 v6, v6, v7
    v_cos_f32 v75, v6
    v_sin_f32 v83, v6
    v_mul_f32 v7, 0x3a000000, v3
    v_add_f32 v7, 0x3c000000, v7
    v_mul_f32 v6, v5, v7
    v_cos_f32 v76, v6
    buffer_load_dwordx4 v131, s[20:23], s96 offen offset:1024 lds
    v_sin_f32 v84, v6
    v_add_f32 v6, v6, v7
    v_cos_f32 v77, v6
    v_sin_f32 v85, v6
    v_add_f32 v6, v6, v7
    v_cos_f32 v78, v6
    buffer_load_dwordx4 v132, s[20:23], s96 offen offset:2048 lds
    v_sin_f32 v86, v6
    v_add_f32 v6, v6, v7
    v_cos_f32 v79, v6
    v_sin_f32 v87, v6
    s_xor_b32 s36, s5, 0
    s_and_b32 s37, s36, 12
    s_lshl_b32 s37, s37, 27
    s_add_u32 m0, m0, 12288
    s_add_u32 s96, s96, 44032
    buffer_load_dwordx4 v130, s[20:23], s96 offen offset:0 lds
    s_and_b32 s36, s36, 3
    s_lshl_b32 s36, s36, 13
    s_or_b32 s36, s36, s37
    v_and_b32 v5, 1, v0
    v_lshlrev_b32 v5, 14, v5
    v_and_b32 v6, 2, v0
    v_lshl_or_b32 v5, v6, 28, v5
    v_xor_b32 v127, s36, v5
    v_xor_b32 v128, 0x2000, v127
    v_or_b32 v127, 0x60000000, v127
    buffer_load_dwordx4 v131, s[20:23], s96 offen offset:1024 lds
    v_and_b32 v5, 1, v2
    v_lshlrev_b32 v5, 29, v5
    v_xor_b32 v212, s36, v5
    v_xor_b32 v213, 0x2000, v212
    v_xor_b32 v214, 0x4000, v212
    v_xor_b32 v215, 0x6000, v212
    v_or_b32 v212, 0x60000000, v212
    s_mov_b32 s46, 0x60006000
    v_and_b32 v5, 63, v0
    v_lshrrev_b32 v6, 2, v5
    buffer_load_dwordx4 v132, s[20:23], s96 offen offset:2048 lds
    v_mul_u32_u24 v7, 384, v6
    v_and_b32 v5, 3, v5
    v_lshl_add_u32 v7, v5, 3, v7
    v_add_u32 v7, 36864, v7
    s_mul_i32 s36, s4, 3
    v_bfe_u32 v6, v6, 1, 2
    s_add_u32 s37, s36, 0
    v_xor_b32 v5, s37, v6
    v_lshl_add_u32 v133, v5, 5, v7
    s_add_u32 s37, s36, 1
    s_add_u32 m0, m0, 12288
    s_add_u32 s96, s96, 44032
    buffer_load_dwordx4 v130, s[20:23], s96 offen offset:0 lds
    v_xor_b32 v5, s37, v6
    v_lshl_add_u32 v134, v5, 5, v7
    s_add_u32 s37, s36, 2
    v_xor_b32 v5, s37, v6
    v_lshl_add_u32 v135, v5, 5, v7
    v_mov_b32 v136, 0x70007000
    v_mov_b32 v137, 0x70007000
    v_mov_b32 v138, 0x70007000
    v_mov_b32 v139, 0x70007000
    v_bfe_u32 v129, v0, 5, 1
    buffer_load_dwordx4 v131, s[20:23], s96 offen offset:1024 lds
    v_mul_u32_u24 v129, 101376, v129
    v_and_or_b32 v129, v0, 31, v129
    v_lshlrev_b32 v129, 4, v129
    s_and_b32 s98, s3, 7
    s_lshl_b32 s98, s98, 2
    s_add_u32 s98, s98, s4
    s_mul_i32 s98, s98, 50688
    s_lshr_b32 s99, s3, 3
    s_lshl_b32 s99, s99, 9
    s_add_u32 s98, s98, s99
    buffer_load_dwordx4 v132, s[20:23], s96 offen offset:2048 lds
    s_add_u32 s99, s98, 6750208
    s_waitcnt vmcnt(12)
    v_xor_b32 v88, v127, v88
    v_xor_b32 v89, v128, v89
    v_or_b32 v5, v88, v89
    s_waitcnt vmcnt(11)
    v_xor_b32 v92, v127, v92
    v_xor_b32 v93, v128, v93
    v_or3_b32 v5, v5, v92, v93
    s_waitcnt vmcnt(10)
    v_xor_b32 v96, v127, v96
    v_xor_b32 v97, v128, v97
    v_or3_b32 v5, v5, v96, v97
    s_waitcnt vmcnt(9)
    v_xor_b32 v100, v127, v100
    v_xor_b32 v101, v128, v101
    v_or3_b32 v5, v5, v100, v101
    v_and_b32 v5, s46, v5
    s_nop 1
    v_or_b32_dpp v5, v5, v5 quad_perm:[1,0,3,2] row_mask:0xf bank_mask:0xf
    s_nop 1
    v_or_b32_dpp v5, v5, v5 quad_perm:[2,3,0,1] row_mask:0xf bank_mask:0xf
    v_cmp_ne_u32 vcc, 0, v5
    s_cbranch_vccnz L_h1slow
L_h1back:
    s_waitcnt vmcnt(13)
    ds_write_b64 v121, v[88:89] offset:0
    ds_write_b64 v122, v[90:91] offset:0
    ds_write_b64 v121, v[92:93] offset:512
    ds_write_b64 v122, v[94:95] offset:1024
    ds_write_b64 v121, v[96:97] offset:1024
    ds_write_b64 v122, v[98:99] offset:2048
    ds_write_b64 v121, v[100:101] offset:1536
    ds_write_b64 v122, v[102:103] offset:3072
    s_waitcnt lgkmcnt(0)
    s_barrier
    s_and_b32 s59, s3, 31
    s_lshl_b32 s59, s59, 2
    s_add_u32 s59, s59, s4
    s_mul_i32 s59, s59, 11264
    v_min_u32 v221, 10, v1
    v_lshlrev_b32 v221, 10, v221
    buffer_load_dword v222, v221, s[24:27], s59 offen offset:384
    ds_read_b128 v[88:91], v123 offset:16384
    ds_read_b128 v[96:99], v123 offset:18496
    ds_read_b128 v[92:95], v123 offset:17408
    ds_read_b128 v[100:103], v123 offset:19520
    ds_read_b128 v[104:107], v123 offset:20608
    ds_read_b128 v[112:115], v123 offset:22720
    ds_read_b128 v[108:111], v123 offset:21632
    ds_read_b128 v[116:119], v123 offset:23744
    ds_read_b128 v[48:51], v124 offset:24832
    ds_read_b128 v[52:55], v124 offset:28992
    s_waitcnt lgkmcnt(9)
    v_mfma_f32_16x16x32_bf16 v[32:35], v[88:91], v[8:11], 0
    ds_read_b64_tr_b16 a[176:177], v133 offset:0
    ds_read_b64_tr_b16 a[180:181], v134 offset:0
    v_mfma_f32_16x16x32_bf16 v[36:39], v[88:91], v[24:27], 0
    ds_read_b64_tr_b16 a[184:185], v135 offset:0
    ds_read_b64_tr_b16 a[178:179], v133 offset:6144
    s_waitcnt lgkmcnt(12)
    v_mfma_f32_16x16x32_bf16 v[32:35], v[96:99], v[16:19], v[32:35]
    ds_read_b64_tr_b16 a[182:183], v134 offset:6144
    ds_read_b64_tr_b16 a[186:187], v135 offset:6144
    v_mfma_f32_16x16x32_bf16 v[36:39], v[96:99], v[8:11], v[36:39]
    ds_read_b64_tr_b16 a[188:189], v133 offset:12288
    ds_read_b64_tr_b16 a[192:193], v134 offset:12288
    s_add_u32 m0, m0, 12288
    s_add_u32 s96, s96, 44032
    buffer_load_dwordx4 v130, s[20:23], s96 offen offset:0 lds
    s_waitcnt lgkmcnt(15)
    v_mfma_f32_16x16x32_bf16 v[32:35], v[92:95], v[12:15], v[32:35]
    ds_read_b64_tr_b16 a[196:197], v135 offset:12288
    ds_read_b64_tr_b16 a[190:191], v133 offset:18432
    v_mfma_f32_16x16x32_bf16 v[36:39], v[92:95], v[28:31], v[36:39]
    ds_read_b64_tr_b16 a[194:195], v134 offset:18432
    ds_read_b64_tr_b16 a[198:199], v135 offset:18432
    s_waitcnt lgkmcnt(15)
    v_mfma_f32_16x16x32_bf16 v[32:35], v[100:103], v[20:23], v[32:35]
    ds_read_b64_tr_b16 a[200:201], v133 offset:24576
    ds_read_b64_tr_b16 a[204:205], v134 offset:24576
    v_mfma_f32_16x16x32_bf16 v[36:39], v[100:103], v[12:15], v[36:39]
    ds_read_b64_tr_b16 a[208:209], v135 offset:24576
    ds_read_b64_tr_b16 a[202:203], v133 offset:30720
    buffer_load_dwordx4 v131, s[20:23], s96 offen offset:1024 lds
    s_waitcnt lgkmcnt(15)
    v_mfma_f32_16x16x32_bf16 v[40:43], v[104:107], v[8:11], 0
    ds_read_b64_tr_b16 a[206:207], v134 offset:30720
    ds_read_b64_tr_b16 a[210:211], v135 offset:30720
    v_mfma_f32_16x16x32_bf16 v[44:47], v[104:107], v[24:27], 0
    ds_read_b64_tr_b16 a[212:213], v133 offset:36864
    ds_read_b64_tr_b16 a[216:217], v134 offset:36864
    s_waitcnt lgkmcnt(15)
    v_mfma_f32_16x16x32_bf16 v[40:43], v[112:115], v[16:19], v[40:43]
    ds_read_b64_tr_b16 a[220:221], v135 offset:36864
    ds_read_b64_tr_b16 a[214:215], v133 offset:43008
    v_mfma_f32_16x16x32_bf16 v[44:47], v[112:115], v[8:11], v[44:47]
    ds_read_b64_tr_b16 a[218:219], v134 offset:43008
    ds_read_b64_tr_b16 a[222:223], v135 offset:43008
    buffer_load_dwordx4 v132, s[20:23], s96 offen offset:2048 lds
    s_waitcnt lgkmcnt(15)
    v_mfma_f32_16x16x32_bf16 v[40:43], v[108:111], v[12:15], v[40:43]
    v_mfma_f32_16x16x32_bf16 v[44:47], v[108:111], v[28:31], v[44:47]
    s_waitcnt lgkmcnt(15)
    v_mfma_f32_16x16x32_bf16 v[40:43], v[116:119], v[20:23], v[40:43]
    v_mfma_f32_16x16x32_bf16 v[44:47], v[116:119], v[12:15], v[44:47]
    s_add_u32 m0, m0, 12288
    s_add_u32 s96, s96, 44032
    buffer_load_dwordx4 v130, s[20:23], s96 offen offset:0 lds
    s_waitcnt vmcnt(11)
    s_barrier
    v_pk_mul_f32 v[88:89], v[32:33], v[56:57]
    v_pk_mul_f32 v[90:91], v[36:37], v[56:57]
    v_pk_fma_f32 v[88:89], v[36:37], v[64:65], v[88:89]
    v_pk_fma_f32 v[90:91], v[32:33], v[64:65], v[90:91] neg_lo:[1,0,0] neg_hi:[1,0,0]
    v_pk_mul_f32 v[92:93], v[34:35], v[58:59]
    v_pk_mul_f32 v[94:95], v[38:39], v[58:59]
    v_pk_fma_f32 v[92:93], v[38:39], v[66:67], v[92:93]
    v_pk_fma_f32 v[94:95], v[34:35], v[66:67], v[94:95] neg_lo:[1,0,0] neg_hi:[1,0,0]
    v_cvt_pk_bf16_f32 v104, v88, v89
    v_cvt_pk_bf16_f32 v108, v90, v91
    v_cvt_pk_bf16_f32 v105, v92, v93
    v_cvt_pk_bf16_f32 v109, v94, v95
    v_pk_mul_f32 v[96:97], v[40:41], v[60:61]
    v_pk_mul_f32 v[98:99], v[44:45], v[60:61]
    v_pk_fma_f32 v[96:97], v[44:45], v[68:69], v[96:97]
    v_pk_fma_f32 v[98:99], v[40:41], v[68:69], v[98:99] neg_lo:[1,0,0] neg_hi:[1,0,0]
    v_pk_mul_f32 v[100:101], v[42:43], v[62:63]
    v_pk_mul_f32 v[102:103], v[46:47], v[62:63]
    buffer_load_dwordx4 v131, s[20:23], s96 offen offset:1024 lds
    v_pk_fma_f32 v[100:101], v[46:47], v[70:71], v[100:101]
    v_pk_fma_f32 v[102:103], v[42:43], v[70:71], v[102:103] neg_lo:[1,0,0] neg_hi:[1,0,0]
    v_cvt_pk_bf16_f32 v106, v96, v97
    v_cvt_pk_bf16_f32 v110, v98, v99
    v_cvt_pk_bf16_f32 v107, v100, v101
    v_cvt_pk_bf16_f32 v111, v102, v103
    s_waitcnt lgkmcnt(15)
    v_mfma_f32_16x16x32_bf16 v[32:35], v[148:151], v[104:107], 0
    v_lshlrev_b32 v56, 16, v48
    v_and_b32 v57, 0xffff0000, v48
    v_mfma_f32_16x16x32_bf16 v[36:39], v[148:151], v[108:111], 0
    v_lshlrev_b32 v64, 16, v52
    v_and_b32 v65, 0xffff0000, v52
    v_mfma_f32_16x16x32_bf16 v[32:35], v[156:159], v[108:111], v[32:35]
    v_lshlrev_b32 v58, 16, v49
    buffer_load_dwordx4 v132, s[20:23], s96 offen offset:2048 lds
    v_and_b32 v59, 0xffff0000, v49
    v_mfma_f32_16x16x32_bf16 v[36:39], v[164:167], v[104:107], v[36:39]
    v_lshlrev_b32 v66, 16, v53
    v_and_b32 v67, 0xffff0000, v53
    v_mfma_f32_16x16x32_bf16 v[40:43], v[152:155], v[104:107], 0
    v_lshlrev_b32 v60, 16, v50
    v_and_b32 v61, 0xffff0000, v50
    v_mfma_f32_16x16x32_bf16 v[44:47], v[152:155], v[108:111], 0
    v_lshlrev_b32 v68, 16, v54
    v_and_b32 v69, 0xffff0000, v54
    v_mfma_f32_16x16x32_bf16 v[40:43], v[160:163], v[108:111], v[40:43]
    v_lshlrev_b32 v62, 16, v51
    v_and_b32 v63, 0xffff0000, v51
    v_mfma_f32_16x16x32_bf16 v[44:47], v[168:171], v[104:107], v[44:47]
    s_add_u32 m0, m0, 12288
    s_add_u32 s96, s96, 44032
    buffer_load_dwordx4 v130, s[20:23], s96 offen offset:0 lds
    v_lshlrev_b32 v70, 16, v55
    v_and_b32 v71, 0xffff0000, v55
    v_pk_mul_f32 v[88:89], v[32:33], v[56:57]
    v_pk_mul_f32 v[90:91], v[36:37], v[56:57]
    v_pk_fma_f32 v[88:89], v[36:37], v[64:65], v[88:89] neg_lo:[1,0,0] neg_hi:[1,0,0]
    v_pk_fma_f32 v[90:91], v[32:33], v[64:65], v[90:91]
    v_pk_mul_f32 v[92:93], v[34:35], v[58:59]
    v_pk_mul_f32 v[94:95], v[38:39], v[58:59]
    v_pk_fma_f32 v[92:93], v[38:39], v[66:67], v[92:93] neg_lo:[1,0,0] neg_hi:[1,0,0]
    v_pk_fma_f32 v[94:95], v[34:35], v[66:67], v[94:95]
    v_cvt_pk_bf16_f32 v104, v88, v89
    v_cvt_pk_bf16_f32 v108, v90, v91
    v_cvt_pk_bf16_f32 v105, v92, v93
    v_cvt_pk_bf16_f32 v109, v94, v95
    v_pk_mul_f32 v[96:97], v[40:41], v[60:61]
    v_pk_mul_f32 v[98:99], v[44:45], v[60:61]
    v_pk_fma_f32 v[96:97], v[44:45], v[68:69], v[96:97] neg_lo:[1,0,0] neg_hi:[1,0,0]
    v_pk_fma_f32 v[98:99], v[40:41], v[68:69], v[98:99]
    buffer_load_dwordx4 v131, s[20:23], s96 offen offset:1024 lds
    v_pk_mul_f32 v[100:101], v[42:43], v[62:63]
    v_pk_mul_f32 v[102:103], v[46:47], v[62:63]
    v_pk_fma_f32 v[100:101], v[46:47], v[70:71], v[100:101] neg_lo:[1,0,0] neg_hi:[1,0,0]
    v_pk_fma_f32 v[102:103], v[42:43], v[70:71], v[102:103]
    v_cvt_pk_bf16_f32 v106, v96, v97
    v_cvt_pk_bf16_f32 v110, v98, v99
    v_cvt_pk_bf16_f32 v107, v100, v101
    v_cvt_pk_bf16_f32 v111, v102, v103
    s_nop 0
    v_mfma_f32_16x16x32_bf16 v[32:35], v[104:107], v[148:151], 0
    ds_read_b64_tr_b16 a[224:225], v133 offset:49152
    ds_read_b64_tr_b16 a[228:229], v134 offset:49152
    v_mfma_f32_16x16x32_bf16 v[36:39], v[108:111], v[148:151], 0
    ds_read_b64_tr_b16 a[232:233], v135 offset:49152
    ds_read_b64_tr_b16 a[226:227], v133 offset:55296
    v_mfma_f32_16x16x32_bf16 v[32:35], v[108:111], v[164:167], v[32:35]
    ds_read_b64_tr_b16 a[230:231], v134 offset:55296
    ds_read_b64_tr_b16 a[234:235], v135 offset:55296
    buffer_load_dwordx4 v132, s[20:23], s96 offen offset:2048 lds
    v_mfma_f32_16x16x32_bf16 v[36:39], v[104:107], v[156:159], v[36:39]
    v_mfma_f32_16x16x32_bf16 v[40:43], v[104:107], v[152:155], 0
    v_mfma_f32_16x16x32_bf16 v[44:47], v[108:111], v[152:155], 0
    v_mfma_f32_16x16x32_bf16 v[40:43], v[108:111], v[168:171], v[40:43]
    v_mfma_f32_16x16x32_bf16 v[44:47], v[104:107], v[160:163], v[44:47]
    buffer_store_dwordx4 v[136:139], v129, s[32:35], s99 offen sc1
    v_pk_mul_f32 v[88:89], v[32:33], v[72:73]
    s_nop 1
    v_pk_mul_f32 v[90:91], v[36:37], v[72:73]
    v_pk_fma_f32 v[88:89], v[36:37], v[80:81], v[88:89] neg_lo:[1,0,0] neg_hi:[1,0,0]
    v_pk_fma_f32 v[90:91], v[32:33], v[80:81], v[90:91]
    v_pk_mul_f32 v[92:93], v[34:35], v[74:75]
    v_pk_mul_f32 v[94:95], v[38:39], v[74:75]
    v_pk_fma_f32 v[92:93], v[38:39], v[82:83], v[92:93] neg_lo:[1,0,0] neg_hi:[1,0,0]
    v_pk_fma_f32 v[94:95], v[34:35], v[82:83], v[94:95]
    v_cvt_pk_bf16_f32 v104, v88, v89
    v_cvt_pk_bf16_f32 v108, v90, v91
    v_cvt_pk_bf16_f32 v105, v92, v93
    v_cvt_pk_bf16_f32 v109, v94, v95
    v_pk_mul_f32 v[96:97], v[40:41], v[76:77]
    v_pk_mul_f32 v[98:99], v[44:45], v[76:77]
    v_pk_fma_f32 v[96:97], v[44:45], v[84:85], v[96:97] neg_lo:[1,0,0] neg_hi:[1,0,0]
    v_pk_fma_f32 v[98:99], v[40:41], v[84:85], v[98:99]
    v_pk_mul_f32 v[100:101], v[42:43], v[78:79]
    v_pk_mul_f32 v[102:103], v[46:47], v[78:79]
    s_add_u32 s99, s98, 6767104
    buffer_store_dwordx4 v[136:139], v129, s[32:35], s99 offen sc1
    v_pk_fma_f32 v[100:101], v[46:47], v[86:87], v[100:101] neg_lo:[1,0,0] neg_hi:[1,0,0]
    v_pk_fma_f32 v[102:103], v[42:43], v[86:87], v[102:103]
    v_cvt_pk_bf16_f32 v106, v96, v97
    v_cvt_pk_bf16_f32 v110, v98, v99
    v_cvt_pk_bf16_f32 v107, v100, v101
    v_cvt_pk_bf16_f32 v111, v102, v103
    ds_write_b64 v125, v[104:105] offset:0
    ds_write_b64 v125, v[108:109] offset:2048
    ds_write_b64 v125, v[106:107] offset:4096
    ds_write_b64 v125, v[110:111] offset:6144
    s_add_u32 s99, s98, 6784000
    buffer_store_dwordx4 v[136:139], v129, s[32:35], s99 offen sc1
    s_waitcnt vmcnt(3)
    s_waitcnt lgkmcnt(0)
    s_barrier
    ds_read_b128 v[88:91], v123 offset:0
    ds_read_b128 v[96:99], v123 offset:2048
    ds_read_b128 v[92:95], v123 offset:1024
    ds_read_b128 v[100:103], v123 offset:3072
    ds_read_b128 v[104:107], v123 offset:4096
    ds_read_b128 v[112:115], v123 offset:6144
    ds_read_b128 v[108:111], v123 offset:5120
    ds_read_b128 v[116:119], v123 offset:7168
    s_waitcnt lgkmcnt(7)
    v_mfma_f32_16x16x32_bf16 v[32:35], v[8:11], v[88:91], 0
    v_add_u32 v144, 61440, v133
    v_add_u32 v145, 61440, v134
    v_add_u32 v146, 61440, v135
    ds_read_b64_tr_b16 a[236:237], v144 offset:0
    s_add_u32 s96, s6, 440320
    s_mul_i32 s97, s4, 3072
    s_add_u32 m0, s97, 16384
    s_nop 0
    buffer_load_dwordx4 v130, s[20:23], s96 offen offset:0 lds
    v_mfma_f32_16x16x32_bf16 v[36:39], v[16:19], v[88:91], 0
    ds_read_b64_tr_b16 a[240:241], v145 offset:0
    s_waitcnt lgkmcnt(8)
    v_mfma_f32_16x16x32_bf16 v[32:35], v[24:27], v[96:99], v[32:35]
    ds_read_b64_tr_b16 a[244:245], v146 offset:0
    v_mfma_f32_16x16x32_bf16 v[36:39], v[8:11], v[96:99], v[36:39]
    ds_read_b64_tr_b16 a[238:239], v144 offset:6144
    s_waitcnt lgkmcnt(9)
    v_mfma_f32_16x16x32_bf16 v[32:35], v[12:15], v[92:95], v[32:35]
    ds_read_b64_tr_b16 a[242:243], v145 offset:6144
    buffer_load_dwordx4 v131, s[20:23], s96 offen offset:1024 lds
    v_mfma_f32_16x16x32_bf16 v[36:39], v[20:23], v[92:95], v[36:39]
    ds_read_b64_tr_b16 a[246:247], v146 offset:6144
    s_waitcnt lgkmcnt(10)
    v_mfma_f32_16x16x32_bf16 v[32:35], v[28:31], v[100:103], v[32:35]
    ds_read_b64_tr_b16 a[248:249], v144 offset:12288
    v_mfma_f32_16x16x32_bf16 v[36:39], v[12:15], v[100:103], v[36:39]
    ds_read_b64_tr_b16 a[252:253], v145 offset:12288
    s_waitcnt lgkmcnt(11)
    v_mfma_f32_16x16x32_bf16 v[40:43], v[8:11], v[104:107], 0
    ds_read_b64_tr_b16 v[252:253], v146 offset:12288
    buffer_load_dwordx4 v132, s[20:23], s96 offen offset:2048 lds
    v_mfma_f32_16x16x32_bf16 v[44:47], v[16:19], v[104:107], 0
    ds_read_b64_tr_b16 a[250:251], v144 offset:18432
    s_waitcnt lgkmcnt(12)
    v_mfma_f32_16x16x32_bf16 v[40:43], v[24:27], v[112:115], v[40:43]
    ds_read_b64_tr_b16 a[254:255], v145 offset:18432
    v_mfma_f32_16x16x32_bf16 v[44:47], v[8:11], v[112:115], v[44:47]
    ds_read_b64_tr_b16 v[254:255], v146 offset:18432
    s_waitcnt lgkmcnt(13)
    v_mfma_f32_16x16x32_bf16 v[40:43], v[12:15], v[108:111], v[40:43]
    v_cvt_pk_bf16_f32 v56, v32, v36
    v_cvt_pk_bf16_f32 v57, v33, v37
    v_mfma_f32_16x16x32_bf16 v[44:47], v[20:23], v[108:111], v[44:47]
    v_cvt_pk_bf16_f32 v58, v34, v38
    v_cvt_pk_bf16_f32 v59, v35, v39
    s_waitcnt lgkmcnt(12)
    v_mfma_f32_16x16x32_bf16 v[40:43], v[28:31], v[116:119], v[40:43]
    v_bfi_b32 v56, s46, v212, v56
    v_bfi_b32 v57, s46, v213, v57
    v_mfma_f32_16x16x32_bf16 v[44:47], v[12:15], v[116:119], v[44:47]
    v_bfi_b32 v58, s46, v214, v58
    v_bfi_b32 v59, s46, v215, v59
    buffer_store_dwordx4 v[56:59], v126, s[32:35], s56 offen offset:0 sc1
    s_nop 4
    v_cvt_pk_bf16_f32 v60, v40, v44
    v_cvt_pk_bf16_f32 v61, v41, v45
    v_cvt_pk_bf16_f32 v62, v42, v46
    v_cvt_pk_bf16_f32 v63, v43, v47
    v_bfi_b32 v60, s46, v212, v60
    v_bfi_b32 v61, s46, v213, v61
    v_bfi_b32 v62, s46, v214, v62
    v_bfi_b32 v63, s46, v215, v63
    buffer_store_dwordx4 v[60:63], v126, s[32:35], s56 offen offset:512 sc1
    s_or_b32 s36, s3, s4
    s_cbranch_scc1 L_gen
    v_mov_b32 v5, s5
    v_mov_b32 v6, 0
    buffer_store_dword v5, v6, s[32:35], 0 offen offset:0
L_gen:
    v_lshrrev_b32 v5, 1, v0
    s_add_u32 m0, m0, 12288
    s_add_u32 s96, s96, 44032
    buffer_load_dwordx4 v130, s[20:23], s96 offen offset:0 lds
    v_and_b32 v6, 1, v0
    v_mul_u32_u24 v7, 8448, v5
    v_lshl_add_u32 v120, v6, 4, v7
    v_lshlrev_b32 v5, 2, v5
    v_lshl_or_b32 v121, v6, 12, v5
    s_lshl_b32 s52, s3, 5
    s_add_u32 s52, s52, 4587520
    s_add_u32 s53, s52, 1081344
    ds_read_b64_tr_b16 v[248:249], v144 offset:24576
    ds_read_b64_tr_b16 v[244:245], v145 offset:24576
    ds_read_b64_tr_b16 v[240:241], v146 offset:24576
    ds_read_b64_tr_b16 v[250:251], v144 offset:30720
    ds_read_b64_tr_b16 v[246:247], v145 offset:30720
    ds_read_b64_tr_b16 v[242:243], v146 offset:30720
    buffer_load_dwordx4 v131, s[20:23], s96 offen offset:1024 lds
    ds_read_b64_tr_b16 v[236:237], v144 offset:36864
    ds_read_b64_tr_b16 v[232:233], v145 offset:36864
    ds_read_b64_tr_b16 v[228:229], v146 offset:36864
    ds_read_b64_tr_b16 v[238:239], v144 offset:43008
    ds_read_b64_tr_b16 v[234:235], v145 offset:43008
    ds_read_b64_tr_b16 v[230:231], v146 offset:43008
    ds_read_b64_tr_b16 v[224:225], v144 offset:49152
    ds_read_b64_tr_b16 v[220:221], v145 offset:49152
    ds_read_b64_tr_b16 v[216:217], v146 offset:49152
    ds_read_b64_tr_b16 v[226:227], v144 offset:55296
    ds_read_b64_tr_b16 v[222:223], v145 offset:55296
    ds_read_b64_tr_b16 v[218:219], v146 offset:55296
    s_xor_b32 s36, s5, 0
    s_and_b32 s37, s36, 12
    buffer_load_dwordx4 v132, s[20:23], s96 offen offset:2048 lds
    s_lshl_b32 s37, s37, 27
    s_and_b32 s36, s36, 3
    s_lshl_b32 s36, s36, 13
    s_or_b32 s36, s36, s37
    v_and_b32 v5, 1, v0
    v_lshlrev_b32 v5, 29, v5
    v_xor_b32 v104, s36, v5
    v_xor_b32 v105, 0x2000, v104
    v_xor_b32 v106, 0x4000, v104
    v_xor_b32 v107, 0x6000, v104
    v_or_b32 v104, 0x60000000, v104
    v_lshlrev_b32 v5, 2, v1
    v_or_b32 v5, v5, v2
    s_lshl_b32 s36, s4, 11
    s_add_u32 m0, m0, 12288
    s_add_u32 s96, s96, 44032
    buffer_load_dwordx4 v130, s[20:23], s96 offen offset:0 lds
    s_add_u32 s36, s36, 8192
    v_lshl_add_u32 v123, v5, 4, s36
    s_and_b32 s36, s3, 7
    s_lshl_b32 s36, s36, 2
    s_add_u32 s36, s36, s4
    s_lshl_b32 s37, s36, 1
    s_and_b32 s37, s37, 15
    v_xor_b32 v5, s37, v5
    v_lshrrev_b32 v6, 5, v5
    v_mul_u32_u24 v6, 16896, v6
    v_and_b32 v5, 31, v5
    v_lshl_add_u32 v124, v5, 4, v6
    v_xor_b32 v125, 16, v124
    s_lshr_b32 s38, s3, 3
    buffer_load_dwordx4 v131, s[20:23], s96 offen offset:1024 lds
    s_lshl_b32 s38, s38, 9
    s_add_u32 s38, s38, 262144
    s_mul_i32 s37, s36, 67584
    s_add_u32 s56, s37, s38
    s_add_u32 s57, s56, 33792
    s_mul_i32 s37, s36, 16896
    s_add_u32 s37, s37, s38
    s_add_u32 s58, s37, 3784704
    v_and_b32 v5, 7, v0
    v_lshlrev_b32 v126, 4, v5
    v_lshlrev_b32 v48, 16, v204
    v_and_b32 v49, 0xffff0000, v204
    v_lshlrev_b32 v50, 16, v205
    v_and_b32 v51, 0xffff0000, v205
    buffer_load_dwordx4 v132, s[20:23], s96 offen offset:2048 lds
    v_lshlrev_b32 v52, 16, v206
    v_and_b32 v53, 0xffff0000, v206
    v_lshlrev_b32 v54, 16, v207
    v_and_b32 v55, 0xffff0000, v207
    v_lshlrev_b32 v56, 16, v208
    v_and_b32 v57, 0xffff0000, v208
    v_lshlrev_b32 v58, 16, v209
    v_and_b32 v59, 0xffff0000, v209
    v_lshlrev_b32 v60, 16, v210
    v_and_b32 v61, 0xffff0000, v210
    v_lshlrev_b32 v62, 16, v211
    v_and_b32 v63, 0xffff0000, v211
    v_pk_add_f32 v[48:49], v[48:49], s[42:43] op_sel:[0,0] op_sel_hi:[1,0] neg_lo:[0,1] neg_hi:[0,1]
    v_pk_add_f32 v[50:51], v[50:51], s[42:43] op_sel:[0,0] op_sel_hi:[1,0] neg_lo:[0,1] neg_hi:[0,1]
    s_add_u32 m0, m0, 12288
    s_add_u32 s96, s96, 44032
    buffer_load_dwordx4 v130, s[20:23], s96 offen offset:0 lds
    v_pk_add_f32 v[52:53], v[52:53], s[42:43] op_sel:[0,0] op_sel_hi:[1,0] neg_lo:[0,1] neg_hi:[0,1]
    v_pk_add_f32 v[54:55], v[54:55], s[42:43] op_sel:[0,0] op_sel_hi:[1,0] neg_lo:[0,1] neg_hi:[0,1]
    v_pk_add_f32 v[56:57], v[56:57], s[42:43] op_sel:[0,1] op_sel_hi:[1,1] neg_lo:[0,1] neg_hi:[0,1]
    v_pk_add_f32 v[58:59], v[58:59], s[42:43] op_sel:[0,1] op_sel_hi:[1,1] neg_lo:[0,1] neg_hi:[0,1]
    v_pk_add_f32 v[60:61], v[60:61], s[42:43] op_sel:[0,1] op_sel_hi:[1,1] neg_lo:[0,1] neg_hi:[0,1]
    v_pk_add_f32 v[62:63], v[62:63], s[42:43] op_sel:[0,1] op_sel_hi:[1,1] neg_lo:[0,1] neg_hi:[0,1]
    v_and_b32 v5, 63, v0
    v_lshrrev_b32 v6, 3, v5
    v_and_b32 v7, 2, v6
    v_xor_b32 v7, v7, v5
    v_and_b32 v7, 7, v7
    v_lshlrev_b32 v7, 4, v7
    v_lshl_or_b32 v136, v6, 10, v7
    v_xor_b32 v7, 64, v136
    buffer_load_dwordx4 v131, s[20:23], s96 offen offset:1024 lds
    v_add_u32 v137, 7168, v7
    v_add_u32 v138, 14336, v136
    v_add_u32 v139, 21504, v7
    s_and_b32 s7, s3, 7
    s_lshl_b32 s7, s7, 7
    s_mul_i32 s36, s4, 360448
    s_add_u32 s7, s7, s36
    v_and_b32 v5, 63, v0
    v_lshrrev_b32 v6, 2, v5
    v_mul_u32_u24 v7, 384, v6
    v_and_b32 v5, 3, v5
    v_lshl_add_u32 v7, v5, 3, v7
    v_add_u32 v7, 16384, v7
    s_mul_i32 s36, s4, 3
    buffer_load_dwordx4 v132, s[20:23], s96 offen offset:2048 lds
    v_bfe_u32 v6, v6, 1, 2
    s_add_u32 s37, s36, 0
    v_xor_b32 v5, s37, v6
    v_lshl_add_u32 v133, v5, 5, v7
    s_add_u32 s37, s36, 1
    v_xor_b32 v5, s37, v6
    v_lshl_add_u32 v134, v5, 5, v7
    s_add_u32 s37, s36, 2
    v_xor_b32 v5, s37, v6
    v_lshl_add_u32 v135, v5, 5, v7
    v_bfe_u32 v5, v0, 5, 1
    v_mul_u32_u24 v5, 1056, v5
    v_and_or_b32 v5, v0, 31, v5
    v_lshlrev_b32 v22, 4, v5
    v_add_u32 v29, 32768, v22
    v_add_u32 v38, 65536, v22
    v_add_u32 v39, 98304, v22
    s_lshl_b32 s51, s4, 12
    s_lshr_b32 s36, s3, 3
    s_lshl_b32 s36, s36, 9
    s_mul_i32 s37, s4, 135168
    s_add_u32 s50, s36, s37
    v_or_b32 v5, 0, v2
    v_xor_b32 v5, v5, v1
    v_lshlrev_b32 v5, 4, v5
    v_lshl_or_b32 v18, v1, 10, v5
    v_or_b32 v5, 4, v2
    v_xor_b32 v5, v5, v1
    v_lshlrev_b32 v5, 4, v5
    v_lshl_or_b32 v19, v1, 10, v5
    v_or_b32 v5, 8, v2
    v_xor_b32 v5, v5, v1
    v_lshlrev_b32 v5, 4, v5
    v_lshl_or_b32 v20, v1, 10, v5
    v_or_b32 v5, 12, v2
    v_xor_b32 v5, v5, v1
    v_lshlrev_b32 v5, 4, v5
    v_lshl_or_b32 v21, v1, 10, v5
    v_and_b32 v5, 63, v0
    v_lshl_add_u32 v25, v5, 4, s51
    s_mov_b32 s40, 0x60000000
    v_and_b32 v5, 1, v2
    v_mul_u32_u24 v6, 16896, v5
    v_lshl_add_u32 v6, v1, 4, v6
    v_lshlrev_b32 v5, 30, v5
    v_lshl_or_b32 v5, v1, 4, v5
    v_add_u32 v5, 33792, v5
    v_lshrrev_b32 v7, 1, v2
    v_lshl_add_u32 v23, v7, 8, v6
    v_lshl_add_u32 v24, v7, 8, v5
    v_mul_u32_u24 v7, 8448, v7
    v_add_u32 v26, v7, v6
    v_add_u32 v27, v7, v5
    s_and_b32 s38, s3, 7
    s_lshl_b32 s39, s38, 2
    s_add_u32 s39, s39, s4
    s_mul_i32 s36, s39, 50688
    s_lshr_b32 s37, s3, 3
    s_lshl_b32 s37, s37, 8
    s_add_u32 s36, s36, s37
    s_add_u32 s10, s36, 4587520
    s_add_u32 s36, s36, s37
    s_add_u32 s8, s36, 6750208
    s_add_u32 s9, s36, 8372224
    s_add_u32 s11, s36, 2424832
    s_and_b32 s39, s39, 15
    s_lshl_b32 s39, s39, 2
    v_or_b32 v5, s39, v2
    v_xor_b32 v5, v5, v1
    v_lshlrev_b32 v5, 4, v5
    v_lshl_or_b32 v5, v1, 10, v5
    s_lshr_b32 s38, s38, 2
    s_lshl_b32 s38, s38, 3
    v_or_b32 v28, s38, v5
    v_and_b32 v5, 63, v0
    v_bfe_u32 v6, v5, 2, 2
    v_lshl_or_b32 v6, v2, 3, v6
    v_and_b32 v7, 3, v5
    v_lshlrev_b32 v7, 3, v7
    v_lshl_or_b32 v7, v6, 7, v7
    v_bfe_u32 v6, v5, 3, 2
    v_xor_b32 v6, s4, v6
    v_lshl_or_b32 v7, v6, 5, v7
    s_lshl_b32 s36, s4, 12
    s_add_u32 s36, s36, 98304
    v_add_u32 v140, s36, v7
    v_xor_b32 v141, 32, v140
    v_xor_b32 v142, 64, v140
    v_xor_b32 v143, 96, v140
    s_waitcnt lgkmcnt(0)
    s_barrier
    buffer_load_dwordx4 v[40:43], v120, s[32:35], s52 offen sc1
    buffer_load_dwordx4 v[44:47], v120, s[32:35], s53 offen sc1
    s_add_u32 m0, m0, 12288
    s_add_u32 s96, s96, 44032
    buffer_load_dwordx4 v130, s[20:23], s96 offen offset:0 lds
    buffer_load_dwordx4 v131, s[20:23], s96 offen offset:1024 lds
    buffer_load_dwordx4 v132, s[20:23], s96 offen offset:2048 lds
    s_add_u32 m0, m0, 12288
    s_add_u32 s96, s96, 44032
    buffer_load_dwordx4 v130, s[20:23], s96 offen offset:0 lds
    buffer_load_dwordx4 v131, s[20:23], s96 offen offset:1024 lds
    buffer_load_dwordx4 v132, s[20:23], s96 offen offset:2048 lds
    s_add_u32 m0, s51, 98304
    s_add_u32 s96, s7, 0
    buffer_load_dwordx4 v136, s[24:27], s96 offen offset:0 lds
    buffer_load_dwordx4 v137, s[24:27], s96 offen offset:1024 lds
    buffer_load_dwordx4 v138, s[24:27], s96 offen offset:2048 lds
    buffer_load_dwordx4 v139, s[24:27], s96 offen offset:3072 lds
    s_waitcnt vmcnt(11)
    v_xor_b32 v40, v104, v40
    v_xor_b32 v41, v105, v41
    v_xor_b32 v42, v106, v42
    v_xor_b32 v43, v107, v43
    v_or_b32 v5, v40, v41
    v_or3_b32 v5, v5, v42, v43
    s_waitcnt vmcnt(10)
    v_xor_b32 v44, v104, v44
    v_xor_b32 v45, v105, v45
    v_xor_b32 v46, v106, v46
    v_xor_b32 v47, v107, v47
    v_or3_b32 v5, v5, v44, v45
    v_or3_b32 v5, v5, v46, v47
    v_and_b32 v5, s46, v5
    s_nop 1
    v_or_b32_dpp v5, v5, v5 quad_perm:[1,0,3,2] row_mask:0xf bank_mask:0xf
    v_cmp_ne_u32 vcc, 0, v5
    s_cbranch_vccnz L_h2slow
L_h2back:
    ds_write2st64_b32 v121, v40, v41 offset0:32 offset1:36
    ds_write2st64_b32 v121, v42, v43 offset0:40 offset1:44
    ds_write2st64_b32 v121, v44, v45 offset0:34 offset1:38
    ds_write2st64_b32 v121, v46, v47 offset0:42 offset1:46
    s_waitcnt lgkmcnt(0)
    s_barrier
    ds_read_b128 v[40:43], v123 offset:0
    s_add_u32 m0, s51, 114688
    s_add_u32 s96, s7, 32768
    buffer_load_dwordx4 v136, s[24:27], s96 offen offset:0 lds
    ds_read_b128 v[44:47], v123 offset:1024
    s_waitcnt lgkmcnt(1)
    v_mfma_f32_16x16x32_bf16 v[88:91], v[40:43], v[180:183], 0
    v_mfma_f32_16x16x32_bf16 v[92:95], v[40:43], v[184:187], 0
    v_mfma_f32_16x16x32_bf16 v[72:75], v[40:43], v[172:175], 0
    v_mfma_f32_16x16x32_bf16 v[76:79], v[40:43], v[176:179], 0
    buffer_load_dwordx4 v137, s[24:27], s96 offen offset:1024 lds
    s_waitcnt lgkmcnt(0)
    v_mfma_f32_16x16x32_bf16 v[96:99], v[44:47], v[180:183], 0
    v_mfma_f32_16x16x32_bf16 v[100:103], v[44:47], v[184:187], 0
    v_mfma_f32_16x16x32_bf16 v[80:83], v[44:47], v[172:175], 0
    v_mfma_f32_16x16x32_bf16 v[84:87], v[44:47], v[176:179], 0
    s_nop 0
    v_cndmask_b32 v72, v72, v88, s[60:61]
    buffer_load_dwordx4 v138, s[24:27], s96 offen offset:2048 lds
    v_cndmask_b32 v76, v76, v92, s[60:61]
    v_pk_mul_f32 v[104:105], v[72:73], v[188:189]
    v_pk_mul_f32 v[106:107], v[76:77], v[188:189]
    v_pk_fma_f32 v[104:105], v[76:77], v[192:193], v[104:105] neg_lo:[1,0,0] neg_hi:[1,0,0]
    v_pk_fma_f32 v[106:107], v[72:73], v[192:193], v[106:107]
    v_pk_mul_f32 v[108:109], v[74:75], v[190:191]
    v_pk_mul_f32 v[110:111], v[78:79], v[190:191]
    v_pk_fma_f32 v[108:109], v[78:79], v[194:195], v[108:109] neg_lo:[1,0,0] neg_hi:[1,0,0]
    v_pk_fma_f32 v[110:111], v[74:75], v[194:195], v[110:111]
    v_cvt_pk_bf16_f32 v40, v104, v106
    v_cvt_pk_bf16_f32 v41, v105, v107
    v_cvt_pk_bf16_f32 v42, v108, v110
    v_cvt_pk_bf16_f32 v43, v109, v111
    s_nop 1
    v_mfma_f32_16x16x32_bf16 v[48:51], v[40:43], v[196:199], v[48:51]
    v_mfma_f32_16x16x32_bf16 v[52:55], v[40:43], v[200:203], v[52:55]
    buffer_load_dwordx4 v139, s[24:27], s96 offen offset:3072 lds
    v_cndmask_b32 v80, v80, v96, s[60:61]
    v_cndmask_b32 v84, v84, v100, s[60:61]
    v_pk_mul_f32 v[112:113], v[80:81], v[188:189]
    v_pk_mul_f32 v[114:115], v[84:85], v[188:189]
    v_pk_fma_f32 v[112:113], v[84:85], v[192:193], v[112:113] neg_lo:[1,0,0] neg_hi:[1,0,0]
    v_pk_fma_f32 v[114:115], v[80:81], v[192:193], v[114:115]
    v_pk_mul_f32 v[116:117], v[82:83], v[190:191]
    v_pk_mul_f32 v[118:119], v[86:87], v[190:191]
    v_pk_fma_f32 v[116:117], v[86:87], v[194:195], v[116:117] neg_lo:[1,0,0] neg_hi:[1,0,0]
    v_pk_fma_f32 v[118:119], v[82:83], v[194:195], v[118:119]
    v_cvt_pk_bf16_f32 v44, v112, v114
    v_cvt_pk_bf16_f32 v45, v113, v115
    v_cvt_pk_bf16_f32 v46, v116, v118
    v_cvt_pk_bf16_f32 v47, v117, v119
    s_nop 1
    v_mfma_f32_16x16x32_bf16 v[56:59], v[44:47], v[196:199], v[56:59]
    v_mfma_f32_16x16x32_bf16 v[60:63], v[44:47], v[200:203], v[60:63]
    v_mov_b32 v74, 0x36a1369a
    v_pk_mul_f32 v[76:77], v[48:49], v[48:49]
    v_pk_fma_f32 v[76:77], v[50:51], v[50:51], v[76:77]
    v_pk_fma_f32 v[76:77], v[52:53], v[52:53], v[76:77]
    v_pk_fma_f32 v[76:77], v[54:55], v[54:55], v[76:77]
    v_add_f32 v72, v76, v77
    s_nop 0
    v_pk_mul_f32 v[80:81], v[56:57], v[56:57]
    v_pk_fma_f32 v[80:81], v[58:59], v[58:59], v[80:81]
    v_pk_fma_f32 v[80:81], v[60:61], v[60:61], v[80:81]
    v_pk_fma_f32 v[80:81], v[62:63], v[62:63], v[80:81]
    v_add_f32 v73, v80, v81
    s_nop 1
    v_permlane32_swap_b32 v72, v73
    v_add_f32 v72, v72, v73
    s_nop 1
    v_add_f32_dpp v72, v72, v72 quad_perm:[1,0,3,2] row_mask:0xf bank_mask:0xf
    s_nop 1
    v_add_f32_dpp v72, v72, v72 quad_perm:[2,3,0,1] row_mask:0xf bank_mask:0xf
    s_nop 1
    v_add_f32_dpp v72, v72, v72 row_ror:4 row_mask:0xf bank_mask:0xf
    s_nop 1
    v_add_f32_dpp v72, v72, v72 row_ror:8 row_mask:0xf bank_mask:0xf
    s_nop 1
    v_add_f32_dpp v72, v72, v72 row_bcast:15 row_mask:0xa bank_mask:0xf
    v_fmac_f32 v74, 0x3a75fdf0, v72
    v_rsq_f32 v72, v74
    s_nop 0
    v_readlane_b32 s62, v72, 31
    v_readlane_b32 s63, v72, 63
    v_mul_f32 v74, v74, v72
    s_nop 0
    v_pk_mul_f32 v[48:49], v[48:49], s[62:63] op_sel:[0,0] op_sel_hi:[1,0]
    v_pk_mul_f32 v[50:51], v[50:51], s[62:63] op_sel:[0,0] op_sel_hi:[1,0]
    v_pk_mul_f32 v[52:53], v[52:53], s[62:63] op_sel:[0,0] op_sel_hi:[1,0]
    v_pk_mul_f32 v[54:55], v[54:55], s[62:63] op_sel:[0,0] op_sel_hi:[1,0]
    v_cvt_pk_bf16_f32 v40, v48, v49
    v_cvt_pk_bf16_f32 v41, v50, v51
    v_cvt_pk_bf16_f32 v42, v52, v53
    v_cvt_pk_bf16_f32 v43, v54, v55
    buffer_store_dwordx4 v[40:43], v124, s[32:35], s56 offen sc1
    v_pk_mul_f32 v[56:57], v[56:57], s[62:63] op_sel:[0,1] op_sel_hi:[1,1]
    v_pk_mul_f32 v[58:59], v[58:59], s[62:63] op_sel:[0,1] op_sel_hi:[1,1]
    v_pk_mul_f32 v[60:61], v[60:61], s[62:63] op_sel:[0,1] op_sel_hi:[1,1]
    v_pk_mul_f32 v[62:63], v[62:63], s[62:63] op_sel:[0,1] op_sel_hi:[1,1]
    v_cvt_pk_bf16_f32 v44, v56, v57
    v_cvt_pk_bf16_f32 v45, v58, v59
    v_cvt_pk_bf16_f32 v46, v60, v61
    v_cvt_pk_bf16_f32 v47, v62, v63
    buffer_store_dwordx4 v[44:47], v125, s[32:35], s57 offen sc1
    v_readlane_b32 s62, v74, 31
    v_readlane_b32 s63, v74, 63
    v_mov_b32 v76, s42
    v_mov_b32 v78, s43
    v_mov_b32 v77, s62
    v_mov_b32 v79, s63
    s_mov_b64 exec, 0xff
    buffer_store_dwordx4 v[76:79], v126, s[32:35], s58 offen sc1
    s_mov_b64 exec, -1
    v_subrev_u32 v120, 32768, v140
    v_subrev_u32 v124, 98304, v140
    v_subrev_u32 v121, 32768, v141
    v_subrev_u32 v125, 98304, v141
    v_subrev_u32 v122, 32768, v142
    v_subrev_u32 v126, 98304, v142
    v_subrev_u32 v123, 32768, v143
    v_subrev_u32 v127, 98304, v143
    s_waitcnt vmcnt(11)
    s_barrier
    s_lshr_b32 s36, s3, 3
    s_add_u32 m0, s51, 131072
    s_add_u32 s96, s7, 65536
    buffer_load_dwordx4 v136, s[24:27], s96 offen offset:0 lds
    s_lshl_b32 s37, s36, 8
    s_add_u32 s38, s37, 4587520
    v_mul_u32_u24 v5, 8448, v2
    v_lshl_add_u32 v5, v1, 4, v5
    v_add_u32 v10, s38, v5
    v_and_b32 v6, 1, v2
    buffer_load_dwordx4 v137, s[24:27], s96 offen offset:1024 lds
    v_mul_u32_u24 v6, 8192, v6
    v_sub_u32 v5, v5, v6
    s_lshl_b32 s37, s36, 9
    s_add_u32 s38, s37, 6750208
    v_add_u32 v8, s38, v5
    s_add_u32 s38, s37, 8372224
    buffer_load_dwordx4 v138, s[24:27], s96 offen offset:2048 lds
    v_add_u32 v9, s38, v5
    s_add_u32 s38, s37, 2424832
    v_add_u32 v11, s38, v5
    s_mul_i32 s12, s4, 371712
    s_add_u32 s13, s12, 33792
    s_add_u32 s14, s12, 67584
    buffer_load_dwordx4 v139, s[24:27], s96 offen offset:3072 lds
    s_add_u32 s15, s12, 101376
    s_add_u32 s16, s12, 135168
    s_add_u32 s17, s12, 168960
    s_add_u32 s18, s12, 202752
    s_add_u32 s19, s12, 236544
    s_add_u32 s20, s12, 270336
    s_add_u32 m0, s51, 147456
    s_add_u32 s96, s7, 98304
    buffer_load_dwordx4 v136, s[24:27], s96 offen offset:0 lds
    s_add_u32 s21, s12, 304128
    s_add_u32 s22, s12, 337920
    v_lshrrev_b32 v5, 1, v1
    v_mul_u32_u24 v5, 16896, v5
    v_and_b32 v6, 1, v1
    v_lshl_add_u32 v16, v6, 3, v5
    buffer_load_dwordx4 v137, s[24:27], s96 offen offset:1024 lds
    s_add_u32 s54, s37, 4046848
    s_add_u32 s55, s37, 4182016
    s_add_u32 s59, s37, 4317184
    s_add_u32 s23, s37, 4452352
    v_and_b32 v5, 63, v0
    v_lshlrev_b32 v5, 4, v5
    buffer_load_dwordx4 v138, s[24:27], s96 offen offset:2048 lds
    s_xor_b32 s38, s4, 0
    s_mul_i32 s39, s38, 12288
    s_add_u32 s39, s39, 0
    v_add_u32 v12, s39, v5
    s_xor_b32 s38, s4, 1
    s_mul_i32 s39, s38, 12288
    buffer_load_dwordx4 v139, s[24:27], s96 offen offset:3072 lds
    s_add_u32 s39, s39, 0
    v_add_u32 v13, s39, v5
    s_xor_b32 s38, s4, 2
    s_mul_i32 s39, s38, 12288
    s_add_u32 s39, s39, 4096
    v_add_u32 v14, s39, v5
    s_xor_b32 s38, s4, 3
    s_mul_i32 s39, s38, 12288
    s_add_u32 s39, s39, 8192
    v_add_u32 v15, s39, v5
    s_and_b32 s38, s3, 7
    s_lshl_b32 s38, s38, 2
    s_add_u32 s38, s38, s4
    s_lshl_b32 s38, s38, 5
    s_lshr_b32 s37, s3, 5
    s_lshl_b32 s37, s37, 8
    s_and_b32 s39, s3, 24
    s_add_u32 s37, s37, s39
    s_lshl_b32 s37, s37, 10
    s_add_u32 s44, s37, s38
    s_add_u32 s45, s44, 4096
    v_and_b32 v5, 7, v1
    v_lshlrev_b32 v5, 15, v5
    v_lshrrev_b32 v6, 3, v1
    v_lshl_or_b32 v5, v6, 10, v5
    v_and_b32 v6, 1, v2
    v_lshl_or_b32 v5, v6, 11, v5
    v_lshrrev_b32 v6, 1, v2
    v_lshl_or_b32 v17, v6, 4, v5
    ds_read_b64_tr_b16 v[212:213], v133 offset:0
    ds_read_b64_tr_b16 v[208:209], v134 offset:0
    ds_read_b64_tr_b16 v[204:205], v135 offset:0
    ds_read_b64_tr_b16 v[214:215], v133 offset:6144
    ds_read_b64_tr_b16 v[210:211], v134 offset:6144
    ds_read_b64_tr_b16 v[206:207], v135 offset:6144
    ds_read_b64_tr_b16 v[200:201], v133 offset:12288
    ds_read_b64_tr_b16 v[196:197], v134 offset:12288
    ds_read_b64_tr_b16 v[192:193], v135 offset:12288
    ds_read_b64_tr_b16 v[202:203], v133 offset:18432
    ds_read_b64_tr_b16 v[198:199], v134 offset:18432
    ds_read_b64_tr_b16 v[194:195], v135 offset:18432
    ds_read_b64_tr_b16 v[188:189], v133 offset:24576
    ds_read_b64_tr_b16 v[184:185], v134 offset:24576
    ds_read_b64_tr_b16 v[180:181], v135 offset:24576
    ds_read_b64_tr_b16 v[190:191], v133 offset:30720
    ds_read_b64_tr_b16 v[186:187], v134 offset:30720
    ds_read_b64_tr_b16 v[182:183], v135 offset:30720
    ds_read_b64_tr_b16 v[176:177], v133 offset:36864
    ds_read_b64_tr_b16 v[172:173], v134 offset:36864
    ds_read_b64_tr_b16 v[168:169], v135 offset:36864
    ds_read_b64_tr_b16 v[178:179], v133 offset:43008
    ds_read_b64_tr_b16 v[174:175], v134 offset:43008
    ds_read_b64_tr_b16 v[170:171], v135 offset:43008
    ds_read_b64_tr_b16 v[164:165], v133 offset:49152
    ds_read_b64_tr_b16 v[160:161], v134 offset:49152
    ds_read_b64_tr_b16 v[156:157], v135 offset:49152
    ds_read_b64_tr_b16 v[166:167], v133 offset:55296
    ds_read_b64_tr_b16 v[162:163], v134 offset:55296
    ds_read_b64_tr_b16 v[158:159], v135 offset:55296
    v_add_u32 v5, 61440, v133
    v_add_u32 v6, 61440, v134
    v_add_u32 v7, 61440, v135
    ds_read_b64_tr_b16 v[152:153], v5 offset:0
    ds_read_b64_tr_b16 v[148:149], v6 offset:0
    ds_read_b64_tr_b16 v[144:145], v7 offset:0
    ds_read_b64_tr_b16 v[154:155], v5 offset:6144
    ds_read_b64_tr_b16 v[150:151], v6 offset:6144
    ds_read_b64_tr_b16 v[146:147], v7 offset:6144
    s_waitcnt lgkmcnt(0)
    s_barrier
    s_add_u32 m0, s51, 0
    s_add_u32 s98, s50, 262144
    buffer_load_dwordx4 v22, s[32:35], s98 offen offset:0 sc1 lds
    buffer_load_dwordx4 v29, s[32:35], s98 offen offset:1024 sc1 lds
    buffer_load_dwordx4 v38, s[32:35], s98 offen offset:2048 sc1 lds
    buffer_load_dwordx4 v39, s[32:35], s98 offen offset:3072 sc1 lds
    s_add_u32 m0, s51, 16384
    s_add_u32 s98, s50, 802816
    buffer_load_dwordx4 v22, s[32:35], s98 offen offset:0 sc1 lds
    buffer_load_dwordx4 v29, s[32:35], s98 offen offset:1024 sc1 lds
    buffer_load_dwordx4 v38, s[32:35], s98 offen offset:2048 sc1 lds
    buffer_load_dwordx4 v39, s[32:35], s98 offen offset:3072 sc1 lds
    s_waitcnt vmcnt(4)
    ds_read2st64_b32 v[116:117], v25 offset0:0 offset1:4
    ds_read2st64_b32 v[118:119], v25 offset0:8 offset1:12
    s_waitcnt lgkmcnt(0)
    v_max3_f32 v116, |v116|, |v117|, |v118|
    v_max_f32 v116, v116, |v119|
    v_cmp_le_f32 vcc, s40, v116
    s_cbranch_vccnz L_gslow0
L_gback0:
    s_barrier
    ds_read_b128 v[64:67], v20 offset:256
    ds_read_b128 v[68:71], v21 offset:256
    ds_read_b128 v[72:75], v18 offset:512
    ds_read_b128 v[76:79], v19 offset:512
    ds_read_b128 v[80:83], v20 offset:512
    ds_read_b128 v[84:87], v21 offset:512
    s_waitcnt lgkmcnt(4)
    v_mfma_f32_16x16x32_bf16 v[40:43], a[248:251], v[64:67], 0
    s_add_u32 m0, s51, 32768
    ds_read_b128 v[88:91], v18 offset:768
    ds_read_b64_tr_b16 a[0:1], v140 offset:0
    v_mfma_f32_16x16x32_bf16 v[44:47], a[252:255], v[64:67], 0
    s_add_u32 s98, s50, 1343488
    ds_read_b64 v[30:31], v28 offset:0
    ds_read_b64_tr_b16 a[2:3], v140 offset:512
    v_mfma_f32_16x16x32_bf16 v[48:51], v[252:255], v[64:67], 0
    buffer_load_dwordx4 v22, s[32:35], s98 offen offset:0 sc1 lds
    ds_read_b64_tr_b16 a[4:5], v141 offset:0
    v_mfma_f32_16x16x32_bf16 v[40:43], v[248:251], v[68:71], v[40:43]
    ds_read_b128 v[92:95], v19 offset:768
    ds_read_b64_tr_b16 a[6:7], v141 offset:512
    v_mfma_f32_16x16x32_bf16 v[44:47], v[244:247], v[68:71], v[44:47]
    buffer_load_dwordx4 v29, s[32:35], s98 offen offset:1024 sc1 lds
    ds_read_b64_tr_b16 a[8:9], v142 offset:0
    v_mfma_f32_16x16x32_bf16 v[48:51], v[240:243], v[68:71], v[48:51]
    s_waitcnt lgkmcnt(10)
    ds_read_b64_tr_b16 a[10:11], v142 offset:512
    v_mfma_f32_16x16x32_bf16 v[40:43], v[236:239], v[72:75], v[40:43]
    ds_read_b128 v[64:67], v20 offset:768
    ds_read_b64_tr_b16 a[12:13], v143 offset:0
    v_mfma_f32_16x16x32_bf16 v[44:47], v[232:235], v[72:75], v[44:47]
    ds_read_b64_tr_b16 a[14:15], v143 offset:512
    v_mfma_f32_16x16x32_bf16 v[48:51], v[228:231], v[72:75], v[48:51]
    buffer_load_dwordx4 v38, s[32:35], s98 offen offset:2048 sc1 lds
    ds_read_b64_tr_b16 a[16:17], v140 offset:16384
    v_mfma_f32_16x16x32_bf16 v[40:43], v[224:227], v[76:79], v[40:43]
    ds_read_b128 v[68:71], v21 offset:768
    ds_read_b64_tr_b16 a[18:19], v140 offset:16896
    v_mfma_f32_16x16x32_bf16 v[44:47], v[220:223], v[76:79], v[44:47]
    ds_read_b64_tr_b16 a[20:21], v141 offset:16384
    v_mfma_f32_16x16x32_bf16 v[48:51], v[216:219], v[76:79], v[48:51]
    s_waitcnt lgkmcnt(15)
    ds_read_b64_tr_b16 a[22:23], v141 offset:16896
    v_mfma_f32_16x16x32_bf16 v[40:43], v[212:215], v[80:83], v[40:43]
    buffer_load_dwordx4 v39, s[32:35], s98 offen offset:3072 sc1 lds
    ds_read_b128 v[72:75], v18 offset:0
    v_mfma_f32_16x16x32_bf16 v[44:47], v[208:211], v[80:83], v[44:47]
    s_add_u32 m0, s51, 65536
    ds_read_b64_tr_b16 a[24:25], v142 offset:16384
    v_mfma_f32_16x16x32_bf16 v[48:51], v[204:207], v[80:83], v[48:51]
    s_add_u32 s96, s7, 131072
    ds_read_b64_tr_b16 a[26:27], v142 offset:16896
    v_mfma_f32_16x16x32_bf16 v[40:43], v[200:203], v[84:87], v[40:43]
    ds_read_b128 v[76:79], v19 offset:0
    ds_read_b64_tr_b16 a[28:29], v143 offset:16384
    v_mfma_f32_16x16x32_bf16 v[44:47], v[196:199], v[84:87], v[44:47]
    s_waitcnt vmcnt(4)
    ds_read2st64_b32 v[116:117], v25 offset0:64 offset1:68
    ds_read2st64_b32 v[118:119], v25 offset0:72 offset1:76
    v_mfma_f32_16x16x32_bf16 v[48:51], v[192:195], v[84:87], v[48:51]
    s_waitcnt lgkmcnt(15)
    buffer_load_dwordx4 v136, s[24:27], s96 offen offset:0 lds
    ds_read_b64_tr_b16 a[30:31], v143 offset:16896
    v_mfma_f32_16x16x32_bf16 v[40:43], v[188:191], v[88:91], v[40:43]
    ds_read_b128 v[80:83], v20 offset:0
    ds_read_b64_tr_b16 a[32:33], v140 offset:32768
    v_mfma_f32_16x16x32_bf16 v[44:47], v[184:187], v[88:91], v[44:47]
    ds_read_b64_tr_b16 a[34:35], v140 offset:33280
    v_mfma_f32_16x16x32_bf16 v[48:51], v[180:183], v[88:91], v[48:51]
    buffer_load_dwordx4 v137, s[24:27], s96 offen offset:1024 lds
    ds_read_b64_tr_b16 a[36:37], v141 offset:32768
    v_mfma_f32_16x16x32_bf16 v[40:43], v[176:179], v[92:95], v[40:43]
    ds_read_b128 v[84:87], v21 offset:0
    ds_read_b64_tr_b16 a[38:39], v141 offset:33280
    v_mfma_f32_16x16x32_bf16 v[44:47], v[172:175], v[92:95], v[44:47]
    ds_read_b64_tr_b16 a[40:41], v142 offset:32768
    v_mfma_f32_16x16x32_bf16 v[48:51], v[168:171], v[92:95], v[48:51]
    s_waitcnt lgkmcnt(15)
    ds_read_b64_tr_b16 a[42:43], v142 offset:33280
    v_mfma_f32_16x16x32_bf16 v[40:43], v[164:167], v[64:67], v[40:43]
    buffer_load_dwordx4 v138, s[24:27], s96 offen offset:2048 lds
    ds_read_b128 v[88:91], v18 offset:256
    v_mfma_f32_16x16x32_bf16 v[44:47], v[160:163], v[64:67], v[44:47]
    s_waitcnt lgkmcnt(10)
    v_max3_f32 v116, |v116|, |v117|, |v118|
    v_max_f32 v116, v116, |v119|
    v_mfma_f32_16x16x32_bf16 v[48:51], v[156:159], v[64:67], v[48:51]
    v_cmp_le_f32 vcc, s40, v116
    ds_read_b64_tr_b16 a[44:45], v143 offset:32768
    v_mfma_f32_16x16x32_bf16 v[40:43], v[152:155], v[68:71], v[40:43]
    s_cbranch_vccnz L_gslow1
L_gback1:
    ds_read_b128 v[92:95], v19 offset:256
    ds_read_b64_tr_b16 a[46:47], v143 offset:33280
    v_mfma_f32_16x16x32_bf16 v[44:47], v[148:151], v[68:71], v[44:47]
    s_barrier
    buffer_load_dwordx4 v139, s[24:27], s96 offen offset:3072 lds
    ds_read_b64_tr_b16 a[48:49], v140 offset:49152
    v_mfma_f32_16x16x32_bf16 v[48:51], v[144:147], v[68:71], v[48:51]
    s_waitcnt lgkmcnt(15)
    ds_read_b64_tr_b16 a[50:51], v140 offset:49664
    v_mfma_f32_16x16x32_bf16 v[40:43], a[176:179], v[72:75], v[40:43]
    s_add_u32 m0, s51, 49152
    ds_read_b128 v[64:67], v20 offset:16640
    ds_read_b64_tr_b16 a[52:53], v141 offset:49152
    v_mfma_f32_16x16x32_bf16 v[44:47], a[180:183], v[72:75], v[44:47]
    s_add_u32 s98, s50, 1884160
    ds_read_b64_tr_b16 a[54:55], v141 offset:49664
    v_mfma_f32_16x16x32_bf16 v[48:51], a[184:187], v[72:75], v[48:51]
    buffer_load_dwordx4 v22, s[32:35], s98 offen offset:0 sc1 lds
    ds_read_b64_tr_b16 a[56:57], v142 offset:49152
    v_mfma_f32_16x16x32_bf16 v[40:43], a[188:191], v[76:79], v[40:43]
    ds_read_b128 v[68:71], v21 offset:16640
    ds_read_b64_tr_b16 a[58:59], v142 offset:49664
    v_mfma_f32_16x16x32_bf16 v[44:47], a[192:195], v[76:79], v[44:47]
    ds_read_b64_tr_b16 a[60:61], v143 offset:49152
    v_mfma_f32_16x16x32_bf16 v[48:51], a[196:199], v[76:79], v[48:51]
    s_waitcnt lgkmcnt(15)
    ds_read_b64_tr_b16 a[62:63], v143 offset:49664
    v_mfma_f32_16x16x32_bf16 v[40:43], a[200:203], v[80:83], v[40:43]
    buffer_load_dwordx4 v29, s[32:35], s98 offen offset:1024 sc1 lds
    ds_read_b128 v[72:75], v18 offset:16896
    v_mfma_f32_16x16x32_bf16 v[44:47], a[204:207], v[80:83], v[44:47]
    v_mfma_f32_16x16x32_bf16 v[48:51], a[208:211], v[80:83], v[48:51]
    v_mfma_f32_16x16x32_bf16 v[40:43], a[212:215], v[84:87], v[40:43]
    ds_read_b128 v[76:79], v19 offset:16896
    v_mfma_f32_16x16x32_bf16 v[44:47], a[216:219], v[84:87], v[44:47]
    buffer_load_dwordx4 v38, s[32:35], s98 offen offset:2048 sc1 lds
    v_mfma_f32_16x16x32_bf16 v[48:51], a[220:223], v[84:87], v[48:51]
    s_waitcnt lgkmcnt(13)
    v_mfma_f32_16x16x32_bf16 v[40:43], a[224:227], v[88:91], v[40:43]
    ds_read_b128 v[80:83], v20 offset:16896
    v_mfma_f32_16x16x32_bf16 v[44:47], a[228:231], v[88:91], v[44:47]
    v_mfma_f32_16x16x32_bf16 v[48:51], a[232:235], v[88:91], v[48:51]
    buffer_load_dwordx4 v39, s[32:35], s98 offen offset:3072 sc1 lds
    v_mfma_f32_16x16x32_bf16 v[40:43], a[236:239], v[92:95], v[40:43]
    s_add_u32 m0, s51, 81920
    ds_read_b128 v[84:87], v21 offset:16896
    v_mfma_f32_16x16x32_bf16 v[44:47], a[240:243], v[92:95], v[44:47]
    s_add_u32 s96, s7, 163840
    v_mfma_f32_16x16x32_bf16 v[48:51], a[244:247], v[92:95], v[48:51]
    s_waitcnt lgkmcnt(7)
    v_mfma_f32_16x16x32_bf16 v[52:55], a[248:251], v[64:67], 0
    buffer_load_dwordx4 v136, s[24:27], s96 offen offset:0 lds
    ds_read_b128 v[88:91], v18 offset:17152
    v_mfma_f32_16x16x32_bf16 v[56:59], a[252:255], v[64:67], 0
    ds_read_b64 v[32:33], v28 offset:16384
    v_mfma_f32_16x16x32_bf16 v[60:63], v[252:255], v[64:67], 0
    v_mfma_f32_16x16x32_bf16 v[52:55], v[248:251], v[68:71], v[52:55]
    ds_read_b128 v[92:95], v19 offset:17152
    v_exp_f32 v96, -v40
    v_mfma_f32_16x16x32_bf16 v[56:59], v[244:247], v[68:71], v[56:59]
    v_exp_f32 v97, -v41
    v_add_f32 v96, 1.0, v96
    v_mfma_f32_16x16x32_bf16 v[60:63], v[240:243], v[68:71], v[60:63]
    s_waitcnt lgkmcnt(5)
    buffer_load_dwordx4 v137, s[24:27], s96 offen offset:1024 lds
    v_add_f32 v97, 1.0, v97
    v_mfma_f32_16x16x32_bf16 v[52:55], v[236:239], v[72:75], v[52:55]
    ds_read_b128 v[64:67], v20 offset:17152
    v_exp_f32 v98, -v42
    v_mfma_f32_16x16x32_bf16 v[56:59], v[232:235], v[72:75], v[56:59]
    v_exp_f32 v99, -v43
    v_add_f32 v98, 1.0, v98
    v_mfma_f32_16x16x32_bf16 v[60:63], v[228:231], v[72:75], v[60:63]
    v_rcp_f32 v96, v96
    v_add_f32 v99, 1.0, v99
    v_mfma_f32_16x16x32_bf16 v[52:55], v[224:227], v[76:79], v[52:55]
    ds_read_b128 v[68:71], v21 offset:17152
    v_mul_f32 v96, v96, v40
    v_mfma_f32_16x16x32_bf16 v[56:59], v[220:223], v[76:79], v[56:59]
    buffer_load_dwordx4 v138, s[24:27], s96 offen offset:2048 lds
    v_rcp_f32 v97, v97
    v_mfma_f32_16x16x32_bf16 v[60:63], v[216:219], v[76:79], v[60:63]
    s_waitcnt lgkmcnt(5)
    v_rcp_f32 v98, v98
    v_mul_f32 v97, v97, v41
    v_mfma_f32_16x16x32_bf16 v[52:55], v[212:215], v[80:83], v[52:55]
    ds_read_b128 v[72:75], v18 offset:16384
    v_mul_f32 v98, v98, v42
    v_cvt_pk_bf16_f32 v108, v96, v97
    v_mfma_f32_16x16x32_bf16 v[56:59], v[208:211], v[80:83], v[56:59]
    v_rcp_f32 v99, v99
    v_mfma_f32_16x16x32_bf16 v[60:63], v[204:207], v[80:83], v[60:63]
    v_exp_f32 v100, -v44
    v_mul_f32 v99, v99, v43
    v_mfma_f32_16x16x32_bf16 v[52:55], v[200:203], v[84:87], v[52:55]
    buffer_load_dwordx4 v139, s[24:27], s96 offen offset:3072 lds
    ds_read_b128 v[76:79], v19 offset:16384
    v_cvt_pk_bf16_f32 v109, v98, v99
    v_mfma_f32_16x16x32_bf16 v[56:59], v[196:199], v[84:87], v[56:59]
    s_waitcnt vmcnt(12)
    ds_read2st64_b32 v[116:117], v25 offset0:128 offset1:132
    ds_read2st64_b32 v[118:119], v25 offset0:136 offset1:140
    v_add_f32 v100, 1.0, v100
    v_mfma_f32_16x16x32_bf16 v[60:63], v[192:195], v[84:87], v[60:63]
    s_waitcnt lgkmcnt(6)
    v_exp_f32 v101, -v45
    v_mfma_f32_16x16x32_bf16 v[52:55], v[188:191], v[88:91], v[52:55]
    s_waitcnt lgkmcnt(13)
    ds_read_b128 v[80:83], v20 offset:16384
    v_add_f32 v101, 1.0, v101
    v_mfma_f32_16x16x32_bf16 v[56:59], v[184:187], v[88:91], v[56:59]
    s_add_u32 m0, s51, 98304
    v_exp_f32 v102, -v46
    v_mfma_f32_16x16x32_bf16 v[60:63], v[180:183], v[88:91], v[60:63]
    s_add_u32 s96, s7, 196608
    v_exp_f32 v103, -v47
    v_add_f32 v102, 1.0, v102
    v_mfma_f32_16x16x32_bf16 v[52:55], v[176:179], v[92:95], v[52:55]
    buffer_load_dwordx4 v136, s[24:27], s96 offen offset:0 lds
    ds_read_b128 v[84:87], v21 offset:16384
    v_add_f32 v103, 1.0, v103
    v_mfma_f32_16x16x32_bf16 v[56:59], v[172:175], v[92:95], v[56:59]
    v_rcp_f32 v100, v100
    v_mfma_f32_16x16x32_bf16 v[60:63], v[168:171], v[92:95], v[60:63]
    s_waitcnt lgkmcnt(6)
    v_rcp_f32 v101, v101
    v_mul_f32 v100, v100, v44
    v_mfma_f32_16x16x32_bf16 v[52:55], v[164:167], v[64:67], v[52:55]
    ds_read_b128 v[88:91], v18 offset:16640
    v_mul_f32 v101, v101, v45
    v_cvt_pk_bf16_f32 v110, v100, v101
    v_mfma_f32_16x16x32_bf16 v[56:59], v[160:163], v[64:67], v[56:59]
    s_waitcnt lgkmcnt(3)
    v_max3_f32 v116, |v116|, |v117|, |v118|
    v_max_f32 v116, v116, |v119|
    v_permlane16_swap_b32 v108, v110
    v_mfma_f32_16x16x32_bf16 v[60:63], v[156:159], v[64:67], v[60:63]
    v_cmp_le_f32 vcc, s40, v116
    buffer_load_dwordx4 v137, s[24:27], s96 offen offset:1024 lds
    v_mfma_f32_16x16x32_bf16 v[52:55], v[152:155], v[68:71], v[52:55]
    s_cbranch_vccnz L_gslow2
L_gback2:
    ds_read_b128 v[92:95], v19 offset:16640
    v_rcp_f32 v102, v102
    v_mfma_f32_16x16x32_bf16 v[56:59], v[148:151], v[68:71], v[56:59]
    s_barrier
    v_rcp_f32 v103, v103
    v_mul_f32 v102, v102, v46
    v_mfma_f32_16x16x32_bf16 v[60:63], v[144:147], v[68:71], v[60:63]
    s_waitcnt lgkmcnt(6)
    v_exp_f32 v104, -v48
    v_mul_f32 v103, v103, v47
    v_mfma_f32_16x16x32_bf16 v[52:55], a[176:179], v[72:75], v[52:55]
    buffer_load_dwordx4 v138, s[24:27], s96 offen offset:2048 lds
    ds_read_b128 v[64:67], v20 offset:33024
    v_cvt_pk_bf16_f32 v111, v102, v103
    v_mfma_f32_16x16x32_bf16 v[56:59], a[180:183], v[72:75], v[56:59]
    v_exp_f32 v105, -v49
    v_permlane16_swap_b32 v109, v111
    v_mfma_f32_16x16x32_bf16 v[60:63], a[184:187], v[72:75], v[60:63]
    v_exp_f32 v106, -v50
    buffer_store_dwordx4 v[108:111], v23, s[32:35], s8 offen sc1
    v_mfma_f32_16x16x32_bf16 v[52:55], a[188:191], v[76:79], v[52:55]
    ds_read_b128 v[68:71], v21 offset:33024
    v_add_f32 v104, 1.0, v104
    v_add_f32 v105, 1.0, v105
    v_mfma_f32_16x16x32_bf16 v[56:59], a[192:195], v[76:79], v[56:59]
    v_exp_f32 v107, -v51
    v_mfma_f32_16x16x32_bf16 v[60:63], a[196:199], v[76:79], v[60:63]
    s_waitcnt lgkmcnt(4)
    buffer_load_dwordx4 v139, s[24:27], s96 offen offset:3072 lds
    v_add_f32 v106, 1.0, v106
    v_mfma_f32_16x16x32_bf16 v[52:55], a[200:203], v[80:83], v[52:55]
    s_add_u32 m0, s51, 114688
    ds_read_b128 v[72:75], v18 offset:33280
    v_add_f32 v107, 1.0, v107
    v_mfma_f32_16x16x32_bf16 v[56:59], a[204:207], v[80:83], v[56:59]
    s_add_u32 s96, s7, 229376
    v_rcp_f32 v104, v104
    v_mfma_f32_16x16x32_bf16 v[60:63], a[208:211], v[80:83], v[60:63]
    v_rcp_f32 v105, v105
    v_mfma_f32_16x16x32_bf16 v[52:55], a[212:215], v[84:87], v[52:55]
    ds_read_b128 v[76:79], v19 offset:33280
    v_mul_f32 v104, v104, v48
    v_mfma_f32_16x16x32_bf16 v[56:59], a[216:219], v[84:87], v[56:59]
    buffer_load_dwordx4 v136, s[24:27], s96 offen offset:0 lds
    v_mul_f32 v105, v105, v49
    v_cvt_pk_bf16_f32 v112, v104, v105
    v_mfma_f32_16x16x32_bf16 v[60:63], a[220:223], v[84:87], v[60:63]
    s_waitcnt lgkmcnt(4)
    v_rcp_f32 v106, v106
    v_mfma_f32_16x16x32_bf16 v[52:55], a[224:227], v[88:91], v[52:55]
    ds_read_b128 v[80:83], v20 offset:33280
    v_mul_f32 v106, v106, v50
    v_mfma_f32_16x16x32_bf16 v[56:59], a[228:231], v[88:91], v[56:59]
    v_rcp_f32 v107, v107
    v_mfma_f32_16x16x32_bf16 v[60:63], a[232:235], v[88:91], v[60:63]
    v_mul_f32 v107, v107, v51
    v_cvt_pk_bf16_f32 v113, v106, v107
    v_mfma_f32_16x16x32_bf16 v[52:55], a[236:239], v[92:95], v[52:55]
    buffer_load_dwordx4 v137, s[24:27], s96 offen offset:1024 lds
    ds_read_b128 v[84:87], v21 offset:33280
    v_mfma_f32_16x16x32_bf16 v[56:59], a[240:243], v[92:95], v[56:59]
    v_permlane16_swap_b32 v112, v114
    v_permlane16_swap_b32 v113, v115
    v_mfma_f32_16x16x32_bf16 v[60:63], a[244:247], v[92:95], v[60:63]
    s_waitcnt lgkmcnt(4)
    buffer_store_dwordx4 v[112:115], v24, s[32:35], s8 offen sc1
    v_mfma_f32_16x16x32_bf16 v[40:43], a[248:251], v[64:67], 0
    ds_read_b128 v[88:91], v18 offset:33536
    v_mfma_f32_16x16x32_bf16 v[44:47], a[252:255], v[64:67], 0
    ds_read_b64 v[34:35], v28 offset:32768
    v_mfma_f32_16x16x32_bf16 v[48:51], v[252:255], v[64:67], 0
    buffer_load_dwordx4 v138, s[24:27], s96 offen offset:2048 lds
    v_mfma_f32_16x16x32_bf16 v[40:43], v[248:251], v[68:71], v[40:43]
    ds_read_b128 v[92:95], v19 offset:33536
    v_exp_f32 v96, -v52
    v_mfma_f32_16x16x32_bf16 v[44:47], v[244:247], v[68:71], v[44:47]
    v_exp_f32 v97, -v53
    v_add_f32 v96, 1.0, v96
    v_mfma_f32_16x16x32_bf16 v[48:51], v[240:243], v[68:71], v[48:51]
    s_waitcnt lgkmcnt(5)
    v_exp_f32 v98, -v54
    v_add_f32 v97, 1.0, v97
    v_mfma_f32_16x16x32_bf16 v[40:43], v[236:239], v[72:75], v[40:43]
    ds_read_b128 v[64:67], v20 offset:33536
    v_add_f32 v98, 1.0, v98
    v_mfma_f32_16x16x32_bf16 v[44:47], v[232:235], v[72:75], v[44:47]
    buffer_load_dwordx4 v139, s[24:27], s96 offen offset:3072 lds
    v_exp_f32 v99, -v55
    v_mfma_f32_16x16x32_bf16 v[48:51], v[228:231], v[72:75], v[48:51]
    s_add_u32 m0, s51, 131072
    v_rcp_f32 v96, v96
    v_add_f32 v99, 1.0, v99
    v_mfma_f32_16x16x32_bf16 v[40:43], v[224:227], v[76:79], v[40:43]
    s_add_u32 s96, s7, 262144
    ds_read_b128 v[68:71], v21 offset:33536
    v_mul_f32 v96, v96, v52
    v_mfma_f32_16x16x32_bf16 v[44:47], v[220:223], v[76:79], v[44:47]
    v_rcp_f32 v97, v97
    v_mfma_f32_16x16x32_bf16 v[48:51], v[216:219], v[76:79], v[48:51]
    s_waitcnt lgkmcnt(5)
    v_rcp_f32 v98, v98
    v_mul_f32 v97, v97, v53
    v_mfma_f32_16x16x32_bf16 v[40:43], v[212:215], v[80:83], v[40:43]
    buffer_load_dwordx4 v136, s[24:27], s96 offen offset:0 lds
    ds_read_b128 v[72:75], v18 offset:32768
    v_mul_f32 v98, v98, v54
    v_mfma_f32_16x16x32_bf16 v[44:47], v[208:211], v[80:83], v[44:47]
    v_rcp_f32 v99, v99
    v_cvt_pk_bf16_f32 v108, v96, v97
    v_mfma_f32_16x16x32_bf16 v[48:51], v[204:207], v[80:83], v[48:51]
    v_exp_f32 v100, -v56
    v_mul_f32 v99, v99, v55
    v_mfma_f32_16x16x32_bf16 v[40:43], v[200:203], v[84:87], v[40:43]
    ds_read_b128 v[76:79], v19 offset:32768
    v_cvt_pk_bf16_f32 v109, v98, v99
    v_add_f32 v100, 1.0, v100
    v_mfma_f32_16x16x32_bf16 v[44:47], v[196:199], v[84:87], v[44:47]
    s_waitcnt vmcnt(15)
    ds_read2st64_b32 v[116:117], v25 offset0:192 offset1:196
    ds_read2st64_b32 v[118:119], v25 offset0:200 offset1:204
    v_mfma_f32_16x16x32_bf16 v[48:51], v[192:195], v[84:87], v[48:51]
    s_waitcnt lgkmcnt(6)
    buffer_load_dwordx4 v137, s[24:27], s96 offen offset:1024 lds
    v_exp_f32 v101, -v57
    v_mfma_f32_16x16x32_bf16 v[40:43], v[188:191], v[88:91], v[40:43]
    ds_read_b128 v[80:83], v20 offset:32768
    v_add_f32 v101, 1.0, v101
    v_mfma_f32_16x16x32_bf16 v[44:47], v[184:187], v[88:91], v[44:47]
    v_exp_f32 v102, -v58
    v_mfma_f32_16x16x32_bf16 v[48:51], v[180:183], v[88:91], v[48:51]
    v_exp_f32 v103, -v59
    v_add_f32 v102, 1.0, v102
    v_mfma_f32_16x16x32_bf16 v[40:43], v[176:179], v[92:95], v[40:43]
    ds_read_b128 v[84:87], v21 offset:32768
    v_add_f32 v103, 1.0, v103
    v_mfma_f32_16x16x32_bf16 v[44:47], v[172:175], v[92:95], v[44:47]
    buffer_load_dwordx4 v138, s[24:27], s96 offen offset:2048 lds
    v_rcp_f32 v100, v100
    v_mfma_f32_16x16x32_bf16 v[48:51], v[168:171], v[92:95], v[48:51]
    s_waitcnt lgkmcnt(6)
    v_rcp_f32 v101, v101
    v_mul_f32 v100, v100, v56
    v_mfma_f32_16x16x32_bf16 v[40:43], v[164:167], v[64:67], v[40:43]
    ds_read_b128 v[88:91], v18 offset:33024
    v_mul_f32 v101, v101, v57
    v_cvt_pk_bf16_f32 v110, v100, v101
    v_mfma_f32_16x16x32_bf16 v[44:47], v[160:163], v[64:67], v[44:47]
    s_waitcnt lgkmcnt(3)
    v_max3_f32 v116, |v116|, |v117|, |v118|
    v_max_f32 v116, v116, |v119|
    v_permlane16_swap_b32 v108, v110
    v_mfma_f32_16x16x32_bf16 v[48:51], v[156:159], v[64:67], v[48:51]
    v_cmp_le_f32 vcc, s40, v116
    v_rcp_f32 v102, v102
    v_mfma_f32_16x16x32_bf16 v[40:43], v[152:155], v[68:71], v[40:43]
    s_cbranch_vccnz L_gslow3
L_gback3:
    buffer_load_dwordx4 v139, s[24:27], s96 offen offset:3072 lds
    ds_read_b128 v[92:95], v19 offset:33024
    v_mul_f32 v102, v102, v58
    v_mfma_f32_16x16x32_bf16 v[44:47], v[148:151], v[68:71], v[44:47]
    s_barrier
    v_rcp_f32 v103, v103
    v_mfma_f32_16x16x32_bf16 v[48:51], v[144:147], v[68:71], v[48:51]
    s_waitcnt lgkmcnt(6)
    v_exp_f32 v104, -v60
    v_mul_f32 v103, v103, v59
    v_mfma_f32_16x16x32_bf16 v[40:43], a[176:179], v[72:75], v[40:43]
    s_add_u32 m0, s51, 147456
    ds_read_b128 v[64:67], v20 offset:49408
    v_cvt_pk_bf16_f32 v111, v102, v103
    v_add_f32 v104, 1.0, v104
    v_mfma_f32_16x16x32_bf16 v[44:47], a[180:183], v[72:75], v[44:47]
    s_add_u32 s96, s7, 294912
    v_exp_f32 v105, -v61
    v_permlane16_swap_b32 v109, v111
    v_mfma_f32_16x16x32_bf16 v[48:51], a[184:187], v[72:75], v[48:51]
    buffer_load_dwordx4 v136, s[24:27], s96 offen offset:0 lds
    buffer_store_dwordx4 v[108:111], v23, s[32:35], s9 offen sc1
    v_add_f32 v105, 1.0, v105
    v_mfma_f32_16x16x32_bf16 v[40:43], a[188:191], v[76:79], v[40:43]
    ds_read_b128 v[68:71], v21 offset:49408
    v_exp_f32 v106, -v62
    v_mfma_f32_16x16x32_bf16 v[44:47], a[192:195], v[76:79], v[44:47]
    v_exp_f32 v107, -v63
    v_mfma_f32_16x16x32_bf16 v[48:51], a[196:199], v[76:79], v[48:51]
    s_waitcnt lgkmcnt(4)
    v_rcp_f32 v104, v104
    v_mfma_f32_16x16x32_bf16 v[40:43], a[200:203], v[80:83], v[40:43]
    ds_read_b128 v[72:75], v18 offset:49664
    v_add_f32 v106, 1.0, v106
    v_mfma_f32_16x16x32_bf16 v[44:47], a[204:207], v[80:83], v[44:47]
    buffer_load_dwordx4 v137, s[24:27], s96 offen offset:1024 lds
    v_add_f32 v107, 1.0, v107
    v_mfma_f32_16x16x32_bf16 v[48:51], a[208:211], v[80:83], v[48:51]
    v_rcp_f32 v105, v105
    v_mfma_f32_16x16x32_bf16 v[40:43], a[212:215], v[84:87], v[40:43]
    ds_read_b128 v[76:79], v19 offset:49664
    v_mul_f32 v104, v104, v60
    v_mfma_f32_16x16x32_bf16 v[44:47], a[216:219], v[84:87], v[44:47]
    v_rcp_f32 v106, v106
    v_mfma_f32_16x16x32_bf16 v[48:51], a[220:223], v[84:87], v[48:51]
    s_waitcnt lgkmcnt(4)
    v_rcp_f32 v107, v107
    v_mfma_f32_16x16x32_bf16 v[40:43], a[224:227], v[88:91], v[40:43]
    buffer_load_dwordx4 v138, s[24:27], s96 offen offset:2048 lds
    ds_read_b128 v[80:83], v20 offset:49664
    v_mul_f32 v105, v105, v61
    v_mfma_f32_16x16x32_bf16 v[44:47], a[228:231], v[88:91], v[44:47]
    v_mul_f32 v106, v106, v62
    v_mul_f32 v107, v107, v63
    v_mfma_f32_16x16x32_bf16 v[48:51], a[232:235], v[88:91], v[48:51]
    v_cvt_pk_bf16_f32 v112, v104, v105
    v_cvt_pk_bf16_f32 v113, v106, v107
    v_mfma_f32_16x16x32_bf16 v[40:43], a[236:239], v[92:95], v[40:43]
    ds_read_b128 v[84:87], v21 offset:49664
    v_permlane16_swap_b32 v112, v114
    v_mfma_f32_16x16x32_bf16 v[44:47], a[240:243], v[92:95], v[44:47]
    v_permlane16_swap_b32 v113, v115
    buffer_store_dwordx4 v[112:115], v24, s[32:35], s9 offen sc1
    v_mfma_f32_16x16x32_bf16 v[48:51], a[244:247], v[92:95], v[48:51]
    s_waitcnt lgkmcnt(4)
    buffer_load_dwordx4 v139, s[24:27], s96 offen offset:3072 lds
    v_mfma_f32_16x16x32_bf16 v[52:55], a[248:251], v[64:67], 0
    s_add_u32 m0, s51, 0
    ds_read_b128 v[88:91], v18 offset:49920
    v_mfma_f32_16x16x32_bf16 v[56:59], a[252:255], v[64:67], 0
    s_add_u32 s96, s7, 327680
    ds_read_b64 v[36:37], v28 offset:49152
    v_mfma_f32_16x16x32_bf16 v[60:63], v[252:255], v[64:67], 0
    v_mfma_f32_16x16x32_bf16 v[52:55], v[248:251], v[68:71], v[52:55]
    ds_read_b128 v[92:95], v19 offset:49920
    v_exp_f32 v96, -v40
    v_mfma_f32_16x16x32_bf16 v[56:59], v[244:247], v[68:71], v[56:59]
    buffer_load_dwordx4 v136, s[24:27], s96 offen offset:0 lds
    v_add_f32 v96, 1.0, v96
    v_mfma_f32_16x16x32_bf16 v[60:63], v[240:243], v[68:71], v[60:63]
    s_waitcnt lgkmcnt(5)
    v_exp_f32 v97, -v41
    v_mfma_f32_16x16x32_bf16 v[52:55], v[236:239], v[72:75], v[52:55]
    ds_read_b128 v[64:67], v20 offset:49920
    v_add_f32 v97, 1.0, v97
    v_mfma_f32_16x16x32_bf16 v[56:59], v[232:235], v[72:75], v[56:59]
    v_exp_f32 v98, -v42
    v_mfma_f32_16x16x32_bf16 v[60:63], v[228:231], v[72:75], v[60:63]
    v_exp_f32 v99, -v43
    v_add_f32 v98, 1.0, v98
    v_mfma_f32_16x16x32_bf16 v[52:55], v[224:227], v[76:79], v[52:55]
    buffer_load_dwordx4 v137, s[24:27], s96 offen offset:1024 lds
    ds_read_b128 v[68:71], v21 offset:49920
    v_add_f32 v99, 1.0, v99
    v_mfma_f32_16x16x32_bf16 v[56:59], v[220:223], v[76:79], v[56:59]
    v_rcp_f32 v96, v96
    v_mfma_f32_16x16x32_bf16 v[60:63], v[216:219], v[76:79], v[60:63]
    s_waitcnt lgkmcnt(5)
    v_rcp_f32 v97, v97
    v_mul_f32 v96, v96, v40
    v_mfma_f32_16x16x32_bf16 v[52:55], v[212:215], v[80:83], v[52:55]
    ds_read_b128 v[72:75], v18 offset:49152
    v_mul_f32 v97, v97, v41
    v_cvt_pk_bf16_f32 v108, v96, v97
    v_mfma_f32_16x16x32_bf16 v[56:59], v[208:211], v[80:83], v[56:59]
    v_rcp_f32 v98, v98
    v_mfma_f32_16x16x32_bf16 v[60:63], v[204:207], v[80:83], v[60:63]
    buffer_load_dwordx4 v138, s[24:27], s96 offen offset:2048 lds
    v_mul_f32 v98, v98, v42
    v_mfma_f32_16x16x32_bf16 v[52:55], v[200:203], v[84:87], v[52:55]
    ds_read_b128 v[76:79], v19 offset:49152
    v_rcp_f32 v99, v99
    v_mfma_f32_16x16x32_bf16 v[56:59], v[196:199], v[84:87], v[56:59]
    v_exp_f32 v100, -v44
    v_mul_f32 v99, v99, v43
    v_mfma_f32_16x16x32_bf16 v[60:63], v[192:195], v[84:87], v[60:63]
    s_waitcnt lgkmcnt(4)
    v_exp_f32 v101, -v45
    v_cvt_pk_bf16_f32 v109, v98, v99
    v_mfma_f32_16x16x32_bf16 v[52:55], v[188:191], v[88:91], v[52:55]
    ds_read_b128 v[80:83], v20 offset:49152
    v_add_f32 v100, 1.0, v100
    v_add_f32 v101, 1.0, v101
    v_mfma_f32_16x16x32_bf16 v[56:59], v[184:187], v[88:91], v[56:59]
    buffer_load_dwordx4 v139, s[24:27], s96 offen offset:3072 lds
    v_exp_f32 v102, -v46
    v_mfma_f32_16x16x32_bf16 v[60:63], v[180:183], v[88:91], v[60:63]
    v_exp_f32 v103, -v47
    v_add_f32 v102, 1.0, v102
    v_mfma_f32_16x16x32_bf16 v[52:55], v[176:179], v[92:95], v[52:55]
    ds_read_b128 v[84:87], v21 offset:49152
    v_add_f32 v103, 1.0, v103
    v_mfma_f32_16x16x32_bf16 v[56:59], v[172:175], v[92:95], v[56:59]
    v_rcp_f32 v100, v100
    v_mfma_f32_16x16x32_bf16 v[60:63], v[168:171], v[92:95], v[60:63]
    s_waitcnt lgkmcnt(4)
    v_rcp_f32 v101, v101
    v_mul_f32 v100, v100, v44
    v_mfma_f32_16x16x32_bf16 v[52:55], v[164:167], v[64:67], v[52:55]
    ds_read_b128 v[88:91], v18 offset:49408
    v_mul_f32 v101, v101, v45
    v_cvt_pk_bf16_f32 v110, v100, v101
    v_mfma_f32_16x16x32_bf16 v[56:59], v[160:163], v[64:67], v[56:59]
    v_rcp_f32 v102, v102
    v_permlane16_swap_b32 v108, v110
    v_mfma_f32_16x16x32_bf16 v[60:63], v[156:159], v[64:67], v[60:63]
    v_rcp_f32 v103, v103
    v_mul_f32 v102, v102, v46
    v_mfma_f32_16x16x32_bf16 v[52:55], v[152:155], v[68:71], v[52:55]
    ds_read_b128 v[92:95], v19 offset:49408
    v_mul_f32 v103, v103, v47
    v_cvt_pk_bf16_f32 v111, v102, v103
    v_mfma_f32_16x16x32_bf16 v[56:59], v[148:151], v[68:71], v[56:59]
    v_exp_f32 v104, -v48
    v_permlane16_swap_b32 v109, v111
    v_mfma_f32_16x16x32_bf16 v[60:63], v[144:147], v[68:71], v[60:63]
    s_waitcnt lgkmcnt(4)
    v_exp_f32 v105, -v49
    v_mfma_f32_16x16x32_bf16 v[52:55], a[176:179], v[72:75], v[52:55]
    v_exp_f32 v106, -v50
    v_mfma_f32_16x16x32_bf16 v[56:59], a[180:183], v[72:75], v[56:59]
    v_exp_f32 v107, -v51
    v_mfma_f32_16x16x32_bf16 v[60:63], a[184:187], v[72:75], v[60:63]
    buffer_store_dwordx4 v[108:111], v26, s[32:35], s10 offen sc1
    v_add_f32 v104, 1.0, v104
    v_mfma_f32_16x16x32_bf16 v[52:55], a[188:191], v[76:79], v[52:55]
    v_rcp_f32 v104, v104
    v_mfma_f32_16x16x32_bf16 v[56:59], a[192:195], v[76:79], v[56:59]
    v_add_f32 v105, 1.0, v105
    v_add_f32 v106, 1.0, v106
    v_mfma_f32_16x16x32_bf16 v[60:63], a[196:199], v[76:79], v[60:63]
    s_waitcnt lgkmcnt(2)
    v_rcp_f32 v105, v105
    v_mfma_f32_16x16x32_bf16 v[52:55], a[200:203], v[80:83], v[52:55]
    v_rcp_f32 v106, v106
    v_mfma_f32_16x16x32_bf16 v[56:59], a[204:207], v[80:83], v[56:59]
    v_add_f32 v107, 1.0, v107
    v_mul_f32 v104, v104, v48
    v_mfma_f32_16x16x32_bf16 v[60:63], a[208:211], v[80:83], v[60:63]
    v_rcp_f32 v107, v107
    v_mfma_f32_16x16x32_bf16 v[52:55], a[212:215], v[84:87], v[52:55]
    v_mul_f32 v105, v105, v49
    v_mul_f32 v106, v106, v50
    v_mfma_f32_16x16x32_bf16 v[56:59], a[216:219], v[84:87], v[56:59]
    v_mul_f32 v107, v107, v51
    v_cvt_pk_bf16_f32 v112, v104, v105
    v_mfma_f32_16x16x32_bf16 v[60:63], a[220:223], v[84:87], v[60:63]
    s_waitcnt lgkmcnt(0)
    v_cvt_pk_bf16_f32 v113, v106, v107
    v_permlane16_swap_b32 v112, v114
    v_mfma_f32_16x16x32_bf16 v[52:55], a[224:227], v[88:91], v[52:55]
    v_permlane16_swap_b32 v113, v115
    buffer_store_dwordx4 v[112:115], v27, s[32:35], s10 offen sc1
    v_mfma_f32_16x16x32_bf16 v[56:59], a[228:231], v[88:91], v[56:59]
    v_mfma_f32_16x16x32_bf16 v[60:63], a[232:235], v[88:91], v[60:63]
    v_mfma_f32_16x16x32_bf16 v[52:55], a[236:239], v[92:95], v[52:55]
    v_mfma_f32_16x16x32_bf16 v[56:59], a[240:243], v[92:95], v[56:59]
    v_mfma_f32_16x16x32_bf16 v[60:63], a[244:247], v[92:95], v[60:63]
    s_nop 5
    v_exp_f32 v96, -v52
    v_exp_f32 v97, -v53
    v_exp_f32 v98, -v54
    buffer_load_dwordx4 v[252:255], v8, s[32:35], s12 offen sc1
    v_exp_f32 v99, -v55
    v_add_f32 v96, 1.0, v96
    v_add_f32 v97, 1.0, v97
    v_add_f32 v98, 1.0, v98
    v_add_f32 v99, 1.0, v99
    buffer_load_dwordx4 v[248:251], v8, s[32:35], s13 offen sc1
    v_rcp_f32 v96, v96
    v_rcp_f32 v97, v97
    v_rcp_f32 v98, v98
    buffer_load_dwordx4 v[244:247], v8, s[32:35], s14 offen sc1
    v_rcp_f32 v99, v99
    v_mul_f32 v96, v96, v52
    v_mul_f32 v97, v97, v53
    v_mul_f32 v98, v98, v54
    v_mul_f32 v99, v99, v55
    buffer_load_dwordx4 v[240:243], v8, s[32:35], s15 offen sc1
    v_cvt_pk_bf16_f32 v108, v96, v97
    v_cvt_pk_bf16_f32 v109, v98, v99
    v_exp_f32 v100, -v56
    v_exp_f32 v101, -v57
    buffer_load_dwordx4 v[236:239], v8, s[32:35], s16 offen sc1
    v_exp_f32 v102, -v58
    v_exp_f32 v103, -v59
    v_add_f32 v100, 1.0, v100
    v_add_f32 v101, 1.0, v101
    buffer_load_dwordx4 v[232:235], v8, s[32:35], s17 offen sc1
    v_add_f32 v102, 1.0, v102
    v_add_f32 v103, 1.0, v103
    v_rcp_f32 v100, v100
    v_rcp_f32 v101, v101
    buffer_load_dwordx4 v[228:231], v8, s[32:35], s18 offen sc1
    v_rcp_f32 v102, v102
    v_rcp_f32 v103, v103
    v_mul_f32 v100, v100, v56
    v_mul_f32 v101, v101, v57
    buffer_load_dwordx4 v[224:227], v8, s[32:35], s19 offen sc1
    v_mul_f32 v102, v102, v58
    v_mul_f32 v103, v103, v59
    v_cvt_pk_bf16_f32 v110, v100, v101
    v_cvt_pk_bf16_f32 v111, v102, v103
    s_nop 0
    v_permlane16_swap_b32 v108, v110
    v_permlane16_swap_b32 v109, v111
    buffer_load_dwordx4 v[220:223], v8, s[32:35], s20 offen sc1
    buffer_store_dwordx4 v[108:111], v23, s[32:35], s11 offen sc1
    v_exp_f32 v104, -v60
    v_exp_f32 v105, -v61
    v_exp_f32 v106, -v62
    buffer_load_dwordx4 v[216:219], v8, s[32:35], s21 offen sc1
    v_exp_f32 v107, -v63
    v_add_f32 v104, 1.0, v104
    v_add_f32 v105, 1.0, v105
    v_add_f32 v106, 1.0, v106
    v_add_f32 v107, 1.0, v107
    buffer_load_dwordx4 v[212:215], v8, s[32:35], s22 offen sc1
    v_rcp_f32 v104, v104
    v_rcp_f32 v105, v105
    v_rcp_f32 v106, v106
    buffer_load_dwordx4 v[208:211], v9, s[32:35], s12 offen sc1
    v_rcp_f32 v107, v107
    v_mul_f32 v104, v104, v60
    v_mul_f32 v105, v105, v61
    v_mul_f32 v106, v106, v62
    v_mul_f32 v107, v107, v63
    buffer_load_dwordx4 v[204:207], v9, s[32:35], s13 offen sc1
    v_cvt_pk_bf16_f32 v112, v104, v105
    v_cvt_pk_bf16_f32 v113, v106, v107
    s_nop 0
    v_permlane16_swap_b32 v112, v114
    v_permlane16_swap_b32 v113, v115
    buffer_store_dwordx4 v[112:115], v24, s[32:35], s11 offen sc1
    buffer_load_dwordx4 v[200:203], v9, s[32:35], s14 offen sc1
    s_waitcnt vmcnt(18)
    ds_read_b64_tr_b16 a[64:65], v120 offset:0
    ds_read_b64_tr_b16 a[66:67], v120 offset:512
    ds_read_b64_tr_b16 a[68:69], v121 offset:0
    ds_read_b64_tr_b16 a[70:71], v121 offset:512
    ds_read_b64_tr_b16 a[72:73], v122 offset:0
    ds_read_b64_tr_b16 a[74:75], v122 offset:512
    ds_read_b64_tr_b16 a[76:77], v123 offset:0
    ds_read_b64_tr_b16 a[78:79], v123 offset:512
    ds_read_b64_tr_b16 a[80:81], v120 offset:16384
    ds_read_b64_tr_b16 a[82:83], v120 offset:16896
    ds_read_b64_tr_b16 a[84:85], v121 offset:16384
    ds_read_b64_tr_b16 a[86:87], v121 offset:16896
    ds_read_b64_tr_b16 a[88:89], v122 offset:16384
    ds_read_b64_tr_b16 a[90:91], v122 offset:16896
    ds_read_b64_tr_b16 a[92:93], v123 offset:16384
    ds_read_b64_tr_b16 a[94:95], v123 offset:16896
    ds_read_b64_tr_b16 a[96:97], v140 offset:0
    ds_read_b64_tr_b16 a[98:99], v140 offset:512
    ds_read_b64_tr_b16 a[100:101], v141 offset:0
    ds_read_b64_tr_b16 a[102:103], v141 offset:512
    ds_read_b64_tr_b16 a[104:105], v142 offset:0
    ds_read_b64_tr_b16 a[106:107], v142 offset:512
    ds_read_b64_tr_b16 a[108:109], v143 offset:0
    ds_read_b64_tr_b16 a[110:111], v143 offset:512
    s_waitcnt vmcnt(13)
    v_max3_f32 v72, |v252|, |v248|, |v244|
    v_cmp_le_f32 vcc, s40, v72
    s_cbranch_vccnz L_hslow00
L_hback00:
    v_mfma_f32_16x16x32_bf16 a[180:183], a[4:7], v[252:255], 0
    buffer_load_dwordx4 v[196:199], v9, s[32:35], s15 offen sc1
    v_mfma_f32_16x16x32_bf16 a[184:187], a[8:11], v[252:255], 0
    ds_read_b64_tr_b16 a[112:113], v140 offset:16384
    ds_read_b64_tr_b16 a[114:115], v140 offset:16896
    v_mfma_f32_16x16x32_bf16 a[188:191], a[12:15], v[252:255], 0
    ds_read_b64_tr_b16 a[116:117], v141 offset:16384
    ds_read_b64_tr_b16 a[118:119], v141 offset:16896
    v_mfma_f32_16x16x32_bf16 v[76:79], a[0:3], v[252:255], 0
    ds_read_b64_tr_b16 a[120:121], v142 offset:16384
    ds_read_b64_tr_b16 a[122:123], v142 offset:16896
    v_mfma_f32_16x16x32_bf16 a[180:183], a[20:23], v[248:251], a[180:183]
    buffer_load_dwordx4 v[192:195], v9, s[32:35], s16 offen sc1
    v_mfma_f32_16x16x32_bf16 a[184:187], a[24:27], v[248:251], a[184:187]
    ds_read_b64_tr_b16 a[124:125], v143 offset:16384
    ds_read_b64_tr_b16 a[126:127], v143 offset:16896
    v_mfma_f32_16x16x32_bf16 a[188:191], a[28:31], v[248:251], a[188:191]
    ds_read_b64_tr_b16 a[128:129], v140 offset:32768
    ds_read_b64_tr_b16 a[130:131], v140 offset:33280
    v_mfma_f32_16x16x32_bf16 v[76:79], a[16:19], v[248:251], v[76:79]
    ds_read_b64_tr_b16 a[132:133], v141 offset:32768
    ds_read_b64_tr_b16 a[134:135], v141 offset:33280
    v_mfma_f32_16x16x32_bf16 a[180:183], a[36:39], v[244:247], a[180:183]
    buffer_load_dwordx4 v[188:191], v9, s[32:35], s17 offen sc1
    v_mfma_f32_16x16x32_bf16 a[184:187], a[40:43], v[244:247], a[184:187]
    s_waitcnt vmcnt(13)
    v_max3_f32 v72, |v240|, |v236|, |v232|
    v_mfma_f32_16x16x32_bf16 a[188:191], a[44:47], v[244:247], a[188:191]
    v_cmp_le_f32 vcc, s40, v72
    v_mfma_f32_16x16x32_bf16 v[76:79], a[32:35], v[244:247], v[76:79]
    s_cbranch_vccnz L_hslow01
L_hback01:
    v_mfma_f32_16x16x32_bf16 a[180:183], a[52:55], v[240:243], a[180:183]
    buffer_load_dwordx4 v[184:187], v9, s[32:35], s18 offen sc1
    v_mfma_f32_16x16x32_bf16 a[184:187], a[56:59], v[240:243], a[184:187]
    ds_read_b64_tr_b16 a[136:137], v142 offset:32768
    ds_read_b64_tr_b16 a[138:139], v142 offset:33280
    v_mfma_f32_16x16x32_bf16 a[188:191], a[60:63], v[240:243], a[188:191]
    ds_read_b64_tr_b16 a[140:141], v143 offset:32768
    ds_read_b64_tr_b16 a[142:143], v143 offset:33280
    v_mfma_f32_16x16x32_bf16 v[76:79], a[48:51], v[240:243], v[76:79]
    ds_read_b64_tr_b16 a[144:145], v140 offset:49152
    ds_read_b64_tr_b16 a[146:147], v140 offset:49664
    s_waitcnt lgkmcnt(15)
    v_mfma_f32_16x16x32_bf16 a[180:183], a[68:71], v[236:239], a[180:183]
    buffer_load_dwordx4 v[180:183], v9, s[32:35], s19 offen sc1
    v_mfma_f32_16x16x32_bf16 a[184:187], a[72:75], v[236:239], a[184:187]
    ds_read_b64_tr_b16 a[148:149], v141 offset:49152
    ds_read_b64_tr_b16 a[150:151], v141 offset:49664
    v_mfma_f32_16x16x32_bf16 a[188:191], a[76:79], v[236:239], a[188:191]
    ds_read_b64_tr_b16 a[152:153], v142 offset:49152
    ds_read_b64_tr_b16 a[154:155], v142 offset:49664
    v_mfma_f32_16x16x32_bf16 v[76:79], a[64:67], v[236:239], v[76:79]
    ds_read_b64_tr_b16 a[156:157], v143 offset:49152
    ds_read_b64_tr_b16 a[158:159], v143 offset:49664
    s_waitcnt lgkmcnt(15)
    v_mfma_f32_16x16x32_bf16 a[180:183], a[84:87], v[232:235], a[180:183]
    buffer_load_dwordx4 v[176:179], v9, s[32:35], s20 offen sc1
    v_mfma_f32_16x16x32_bf16 a[184:187], a[88:91], v[232:235], a[184:187]
    s_waitcnt vmcnt(13)
    v_max3_f32 v72, |v228|, |v224|, |v220|
    v_mfma_f32_16x16x32_bf16 a[188:191], a[92:95], v[232:235], a[188:191]
    v_cmp_le_f32 vcc, s40, v72
    v_mfma_f32_16x16x32_bf16 v[76:79], a[80:83], v[232:235], v[76:79]
    s_cbranch_vccnz L_hslow02
L_hback02:
    s_waitcnt lgkmcnt(15)
    v_mfma_f32_16x16x32_bf16 a[180:183], a[100:103], v[228:231], a[180:183]
    buffer_load_dwordx4 v[172:175], v9, s[32:35], s21 offen sc1
    v_mfma_f32_16x16x32_bf16 a[184:187], a[104:107], v[228:231], a[184:187]
    ds_read_b64_tr_b16 a[160:161], v124 offset:0
    ds_read_b64_tr_b16 a[162:163], v124 offset:512
    v_mfma_f32_16x16x32_bf16 a[188:191], a[108:111], v[228:231], a[188:191]
    ds_read_b64_tr_b16 a[164:165], v125 offset:0
    ds_read_b64_tr_b16 a[166:167], v125 offset:512
    v_mfma_f32_16x16x32_bf16 v[76:79], a[96:99], v[228:231], v[76:79]
    ds_read_b64_tr_b16 a[168:169], v126 offset:0
    ds_read_b64_tr_b16 a[170:171], v126 offset:512
    s_waitcnt lgkmcnt(15)
    v_mfma_f32_16x16x32_bf16 a[180:183], a[116:119], v[224:227], a[180:183]
    buffer_load_dwordx4 v[168:171], v9, s[32:35], s22 offen sc1
    v_mfma_f32_16x16x32_bf16 a[184:187], a[120:123], v[224:227], a[184:187]
    ds_read_b64_tr_b16 a[172:173], v127 offset:0
    ds_read_b64_tr_b16 a[174:175], v127 offset:512
    v_mfma_f32_16x16x32_bf16 a[188:191], a[124:127], v[224:227], a[188:191]
    v_mfma_f32_16x16x32_bf16 v[76:79], a[112:115], v[224:227], v[76:79]
    s_waitcnt lgkmcnt(15)
    v_mfma_f32_16x16x32_bf16 a[180:183], a[132:135], v[220:223], a[180:183]
    buffer_load_dwordx4 v[164:167], v10, s[32:35], s12 offen sc1
    v_mfma_f32_16x16x32_bf16 a[184:187], a[136:139], v[220:223], a[184:187]
    s_waitcnt vmcnt(13)
    v_max3_f32 v72, |v216|, |v212|, |v212|
    v_mfma_f32_16x16x32_bf16 a[188:191], a[140:143], v[220:223], a[188:191]
    v_cmp_le_f32 vcc, s40, v72
    v_mfma_f32_16x16x32_bf16 v[76:79], a[128:131], v[220:223], v[76:79]
    s_cbranch_vccnz L_hslow03
L_hback03:
    s_waitcnt lgkmcnt(8)
    v_mfma_f32_16x16x32_bf16 a[180:183], a[148:151], v[216:219], a[180:183]
    buffer_load_dwordx4 v[160:163], v10, s[32:35], s13 offen sc1
    v_mfma_f32_16x16x32_bf16 a[184:187], a[152:155], v[216:219], a[184:187]
    v_mfma_f32_16x16x32_bf16 a[188:191], a[156:159], v[216:219], a[188:191]
    v_mfma_f32_16x16x32_bf16 v[76:79], a[144:147], v[216:219], v[76:79]
    s_waitcnt lgkmcnt(0)
    v_mfma_f32_16x16x32_bf16 a[180:183], a[164:167], v[212:215], a[180:183]
    buffer_load_dwordx4 v[156:159], v10, s[32:35], s14 offen sc1
    v_mfma_f32_16x16x32_bf16 a[184:187], a[168:171], v[212:215], a[184:187]
    s_waitcnt vmcnt(11)
    v_max3_f32 v72, |v208|, |v204|, |v200|
    v_mfma_f32_16x16x32_bf16 a[188:191], a[172:175], v[212:215], a[188:191]
    v_cmp_le_f32 vcc, s40, v72
    v_mfma_f32_16x16x32_bf16 v[76:79], a[160:163], v[212:215], v[76:79]
    s_cbranch_vccnz L_hslow10
L_hback10:
    s_barrier
    v_mfma_f32_16x16x32_bf16 a[196:199], a[4:7], v[208:211], 0
    buffer_load_dwordx4 v[152:155], v10, s[32:35], s15 offen sc1
    v_mfma_f32_16x16x32_bf16 a[200:203], a[8:11], v[208:211], 0
    buffer_load_dwordx2 v[64:65], v16, s[32:35], s54 offen sc1
    buffer_load_dwordx2 v[66:67], v16, s[32:35], s55 offen sc1
    v_mfma_f32_16x16x32_bf16 a[204:207], a[12:15], v[208:211], 0
    buffer_load_dwordx2 v[68:69], v16, s[32:35], s59 offen sc1
    buffer_load_dwordx2 v[70:71], v16, s[32:35], s23 offen sc1
    v_mfma_f32_16x16x32_bf16 v[56:59], a[0:3], v[208:211], 0
    v_mfma_f32_16x16x32_bf16 a[196:199], a[20:23], v[204:207], a[196:199]
    buffer_load_dwordx4 v[148:151], v10, s[32:35], s16 offen sc1
    v_mfma_f32_16x16x32_bf16 a[200:203], a[24:27], v[204:207], a[200:203]
    v_mfma_f32_16x16x32_bf16 a[204:207], a[28:31], v[204:207], a[204:207]
    v_mfma_f32_16x16x32_bf16 v[56:59], a[16:19], v[204:207], v[56:59]
    v_mfma_f32_16x16x32_bf16 a[196:199], a[36:39], v[200:203], a[196:199]
    buffer_load_dwordx4 v[144:147], v10, s[32:35], s17 offen sc1
    v_mfma_f32_16x16x32_bf16 a[200:203], a[40:43], v[200:203], a[200:203]
    s_waitcnt vmcnt(15)
    v_max3_f32 v72, |v196|, |v192|, |v188|
    v_mfma_f32_16x16x32_bf16 a[204:207], a[44:47], v[200:203], a[204:207]
    v_cmp_le_f32 vcc, s40, v72
    v_mfma_f32_16x16x32_bf16 v[56:59], a[32:35], v[200:203], v[56:59]
    s_cbranch_vccnz L_hslow11
L_hback11:
    v_mfma_f32_16x16x32_bf16 a[196:199], a[52:55], v[196:199], a[196:199]
    buffer_load_dwordx4 v[140:143], v10, s[32:35], s18 offen sc1
    v_mfma_f32_16x16x32_bf16 a[200:203], a[56:59], v[196:199], a[200:203]
    ds_write_b128 v13, a[180:183] offset:0
    ds_write_b128 v14, a[184:187] offset:0
    v_mfma_f32_16x16x32_bf16 a[204:207], a[60:63], v[196:199], a[204:207]
    ds_write_b128 v15, a[188:191] offset:0
    v_mfma_f32_16x16x32_bf16 v[56:59], a[48:51], v[196:199], v[56:59]
    v_mfma_f32_16x16x32_bf16 a[196:199], a[68:71], v[192:195], a[196:199]
    buffer_load_dwordx4 v[136:139], v10, s[32:35], s19 offen sc1
    v_mfma_f32_16x16x32_bf16 a[200:203], a[72:75], v[192:195], a[200:203]
    v_mfma_f32_16x16x32_bf16 a[204:207], a[76:79], v[192:195], a[204:207]
    v_mfma_f32_16x16x32_bf16 v[56:59], a[64:67], v[192:195], v[56:59]
    v_mfma_f32_16x16x32_bf16 a[196:199], a[84:87], v[188:191], a[196:199]
    buffer_load_dwordx4 v[132:135], v10, s[32:35], s20 offen sc1
    v_mfma_f32_16x16x32_bf16 a[200:203], a[88:91], v[188:191], a[200:203]
    s_waitcnt vmcnt(15)
    v_max3_f32 v72, |v184|, |v180|, |v176|
    v_mfma_f32_16x16x32_bf16 a[204:207], a[92:95], v[188:191], a[204:207]
    v_cmp_le_f32 vcc, s40, v72
    v_mfma_f32_16x16x32_bf16 v[56:59], a[80:83], v[188:191], v[56:59]
    s_cbranch_vccnz L_hslow12
L_hback12:
    v_mfma_f32_16x16x32_bf16 a[196:199], a[100:103], v[184:187], a[196:199]
    buffer_load_dwordx4 v[128:131], v10, s[32:35], s21 offen sc1
    v_mfma_f32_16x16x32_bf16 a[200:203], a[104:107], v[184:187], a[200:203]
    v_mfma_f32_16x16x32_bf16 a[204:207], a[108:111], v[184:187], a[204:207]
    v_mfma_f32_16x16x32_bf16 v[56:59], a[96:99], v[184:187], v[56:59]
    v_mfma_f32_16x16x32_bf16 a[196:199], a[116:119], v[180:183], a[196:199]
    buffer_load_dwordx4 v[124:127], v10, s[32:35], s22 offen sc1
    v_mfma_f32_16x16x32_bf16 a[200:203], a[120:123], v[180:183], a[200:203]
    v_mfma_f32_16x16x32_bf16 a[204:207], a[124:127], v[180:183], a[204:207]
    v_mfma_f32_16x16x32_bf16 v[56:59], a[112:115], v[180:183], v[56:59]
    v_mfma_f32_16x16x32_bf16 a[196:199], a[132:135], v[176:179], a[196:199]
    buffer_load_dwordx4 v[120:123], v11, s[32:35], s12 offen sc1
    v_mfma_f32_16x16x32_bf16 a[200:203], a[136:139], v[176:179], a[200:203]
    s_waitcnt vmcnt(16)
    v_max3_f32 v72, |v172|, |v168|, |v168|
    v_mfma_f32_16x16x32_bf16 a[204:207], a[140:143], v[176:179], a[204:207]
    v_cmp_le_f32 vcc, s40, v72
    v_mfma_f32_16x16x32_bf16 v[56:59], a[128:131], v[176:179], v[56:59]
    s_cbranch_vccnz L_hslow13
L_hback13:
    v_mfma_f32_16x16x32_bf16 a[196:199], a[148:151], v[172:175], a[196:199]
    buffer_load_dwordx4 v[116:119], v11, s[32:35], s13 offen sc1
    v_mfma_f32_16x16x32_bf16 a[200:203], a[152:155], v[172:175], a[200:203]
    v_mfma_f32_16x16x32_bf16 a[204:207], a[156:159], v[172:175], a[204:207]
    v_mfma_f32_16x16x32_bf16 v[56:59], a[144:147], v[172:175], v[56:59]
    v_mfma_f32_16x16x32_bf16 a[196:199], a[164:167], v[168:171], a[196:199]
    buffer_load_dwordx4 v[112:115], v11, s[32:35], s14 offen sc1
    v_mfma_f32_16x16x32_bf16 a[200:203], a[168:171], v[168:171], a[200:203]
    s_waitcnt vmcnt(15)
    v_max3_f32 v72, |v164|, |v160|, |v156|
    v_mfma_f32_16x16x32_bf16 a[204:207], a[172:175], v[168:171], a[204:207]
    v_cmp_le_f32 vcc, s40, v72
    v_mfma_f32_16x16x32_bf16 v[56:59], a[160:163], v[168:171], v[56:59]
    s_cbranch_vccnz L_hslow20
L_hback20:
    v_mfma_f32_16x16x32_bf16 a[212:215], a[4:7], v[164:167], 0
    buffer_load_dwordx4 v[108:111], v11, s[32:35], s15 offen sc1
    v_mfma_f32_16x16x32_bf16 a[216:219], a[8:11], v[164:167], 0
    v_mfma_f32_16x16x32_bf16 a[220:223], a[12:15], v[164:167], 0
    v_mfma_f32_16x16x32_bf16 v[60:63], a[0:3], v[164:167], 0
    v_mfma_f32_16x16x32_bf16 a[212:215], a[20:23], v[160:163], a[212:215]
    buffer_load_dwordx4 v[104:107], v11, s[32:35], s16 offen sc1
    v_mfma_f32_16x16x32_bf16 a[216:219], a[24:27], v[160:163], a[216:219]
    v_mfma_f32_16x16x32_bf16 a[220:223], a[28:31], v[160:163], a[220:223]
    v_mfma_f32_16x16x32_bf16 v[60:63], a[16:19], v[160:163], v[60:63]
    v_mfma_f32_16x16x32_bf16 a[212:215], a[36:39], v[156:159], a[212:215]
    buffer_load_dwordx4 v[100:103], v11, s[32:35], s17 offen sc1
    v_mfma_f32_16x16x32_bf16 a[216:219], a[40:43], v[156:159], a[216:219]
    s_waitcnt vmcnt(11)
    v_max3_f32 v72, |v152|, |v148|, |v144|
    v_mfma_f32_16x16x32_bf16 a[220:223], a[44:47], v[156:159], a[220:223]
    v_cmp_le_f32 vcc, s40, v72
    v_mfma_f32_16x16x32_bf16 v[60:63], a[32:35], v[156:159], v[60:63]
    s_cbranch_vccnz L_hslow21
L_hback21:
    v_mfma_f32_16x16x32_bf16 a[212:215], a[52:55], v[152:155], a[212:215]
    buffer_load_dwordx4 v[96:99], v11, s[32:35], s18 offen sc1
    v_mfma_f32_16x16x32_bf16 a[216:219], a[56:59], v[152:155], a[216:219]
    ds_write_b128 v13, a[196:199] offset:1024
    ds_write_b128 v14, a[200:203] offset:1024
    v_mfma_f32_16x16x32_bf16 a[220:223], a[60:63], v[152:155], a[220:223]
    ds_write_b128 v15, a[204:207] offset:1024
    v_mfma_f32_16x16x32_bf16 v[60:63], a[48:51], v[152:155], v[60:63]
    s_mov_b32 s62, 0x3f317218
    v_mfma_f32_16x16x32_bf16 a[212:215], a[68:71], v[148:151], a[212:215]
    buffer_load_dwordx4 v[92:95], v11, s[32:35], s19 offen sc1
    v_mfma_f32_16x16x32_bf16 a[216:219], a[72:75], v[148:151], a[216:219]
    s_mov_b32 s63, s62
    v_mfma_f32_16x16x32_bf16 a[220:223], a[76:79], v[148:151], a[220:223]
    s_waitcnt vmcnt(15)
    v_lshlrev_b32 v40, 16, v30
    v_and_b32 v41, 0xffff0000, v30
    v_mfma_f32_16x16x32_bf16 v[60:63], a[64:67], v[148:151], v[60:63]
    v_lshlrev_b32 v42, 16, v31
    v_and_b32 v43, 0xffff0000, v31
    v_mfma_f32_16x16x32_bf16 a[212:215], a[84:87], v[144:147], a[212:215]
    buffer_load_dwordx4 v[88:91], v11, s[32:35], s20 offen sc1
    v_mfma_f32_16x16x32_bf16 a[216:219], a[88:91], v[144:147], a[216:219]
    s_waitcnt vmcnt(11)
    v_max3_f32 v72, |v140|, |v136|, |v132|
    v_mfma_f32_16x16x32_bf16 a[220:223], a[92:95], v[144:147], a[220:223]
    v_cmp_le_f32 vcc, s40, v72
    v_mfma_f32_16x16x32_bf16 v[60:63], a[80:83], v[144:147], v[60:63]
    s_cbranch_vccnz L_hslow22
L_hback22:
    v_mfma_f32_16x16x32_bf16 a[212:215], a[100:103], v[140:143], a[212:215]
    buffer_load_dwordx4 v[84:87], v11, s[32:35], s21 offen sc1
    v_mfma_f32_16x16x32_bf16 a[216:219], a[104:107], v[140:143], a[216:219]
    v_lshlrev_b32 v44, 16, v32
    v_and_b32 v45, 0xffff0000, v32
    v_mfma_f32_16x16x32_bf16 a[220:223], a[108:111], v[140:143], a[220:223]
    v_lshlrev_b32 v46, 16, v33
    v_and_b32 v47, 0xffff0000, v33
    v_mfma_f32_16x16x32_bf16 v[60:63], a[96:99], v[140:143], v[60:63]
    v_fma_f32 v40, v40, v65, v64
    v_fma_f32 v41, v41, v65, v64
    v_mfma_f32_16x16x32_bf16 a[212:215], a[116:119], v[136:139], a[212:215]
    buffer_load_dwordx4 v[80:83], v11, s[32:35], s22 offen sc1
    v_mfma_f32_16x16x32_bf16 a[216:219], a[120:123], v[136:139], a[216:219]
    v_fma_f32 v42, v42, v65, v64
    v_fma_f32 v43, v43, v65, v64
    v_mfma_f32_16x16x32_bf16 a[220:223], a[124:127], v[136:139], a[220:223]
    v_fma_f32 v44, v44, v67, v66
    v_fma_f32 v45, v45, v67, v66
    v_mfma_f32_16x16x32_bf16 v[60:63], a[112:115], v[136:139], v[60:63]
    v_fma_f32 v46, v46, v67, v66
    v_fma_f32 v47, v47, v67, v66
    v_mfma_f32_16x16x32_bf16 a[212:215], a[132:135], v[132:135], a[212:215]
    v_mfma_f32_16x16x32_bf16 a[216:219], a[136:139], v[132:135], a[216:219]
    s_waitcnt vmcnt(11)
    v_max3_f32 v72, |v128|, |v124|, |v124|
    v_mfma_f32_16x16x32_bf16 a[220:223], a[140:143], v[132:135], a[220:223]
    v_cmp_le_f32 vcc, s40, v72
    v_mfma_f32_16x16x32_bf16 v[60:63], a[128:131], v[132:135], v[60:63]
    s_cbranch_vccnz L_hslow23
L_hback23:
    v_mfma_f32_16x16x32_bf16 a[212:215], a[148:151], v[128:131], a[212:215]
    s_waitcnt lgkmcnt(0)
    v_mfma_f32_16x16x32_bf16 a[216:219], a[152:155], v[128:131], a[216:219]
    s_barrier
    ds_read_b128 v[208:211], v12 offset:0
    ds_read_b128 v[212:215], v12 offset:4096
    v_mfma_f32_16x16x32_bf16 a[220:223], a[156:159], v[128:131], a[220:223]
    ds_read_b128 v[216:219], v12 offset:8192
    ds_read_b128 v[220:223], v12 offset:1024
    v_mfma_f32_16x16x32_bf16 v[60:63], a[144:147], v[128:131], v[60:63]
    ds_read_b128 v[224:227], v12 offset:5120
    ds_read_b128 v[228:231], v12 offset:9216
    v_mfma_f32_16x16x32_bf16 a[212:215], a[164:167], v[124:127], a[212:215]
    v_mfma_f32_16x16x32_bf16 a[216:219], a[168:171], v[124:127], a[216:219]
    s_waitcnt vmcnt(8)
    v_max3_f32 v72, |v120|, |v116|, |v112|
    v_mfma_f32_16x16x32_bf16 a[220:223], a[172:175], v[124:127], a[220:223]
    v_cmp_le_f32 vcc, s40, v72
    v_mfma_f32_16x16x32_bf16 v[60:63], a[160:163], v[124:127], v[60:63]
    s_cbranch_vccnz L_hslow30
L_hback30:
    v_mfma_f32_16x16x32_bf16 a[228:231], a[4:7], v[120:123], 0
    v_lshlrev_b32 v48, 16, v34
    v_and_b32 v49, 0xffff0000, v34
    v_mfma_f32_16x16x32_bf16 a[232:235], a[8:11], v[120:123], 0
    v_lshlrev_b32 v50, 16, v35
    v_and_b32 v51, 0xffff0000, v35
    v_mfma_f32_16x16x32_bf16 a[236:239], a[12:15], v[120:123], 0
    v_lshlrev_b32 v52, 16, v36
    v_and_b32 v53, 0xffff0000, v36
    v_mfma_f32_16x16x32_bf16 v[24:27], a[0:3], v[120:123], 0
    v_lshlrev_b32 v54, 16, v37
    v_and_b32 v55, 0xffff0000, v37
    v_mfma_f32_16x16x32_bf16 a[228:231], a[20:23], v[116:119], a[228:231]
    v_fma_f32 v48, v48, v69, v68
    v_fma_f32 v49, v49, v69, v68
    v_mfma_f32_16x16x32_bf16 a[232:235], a[24:27], v[116:119], a[232:235]
    v_fma_f32 v50, v50, v69, v68
    v_fma_f32 v51, v51, v69, v68
    v_mfma_f32_16x16x32_bf16 a[236:239], a[28:31], v[116:119], a[236:239]
    v_fma_f32 v52, v52, v71, v70
    v_fma_f32 v53, v53, v71, v70
    v_mfma_f32_16x16x32_bf16 v[24:27], a[16:19], v[116:119], v[24:27]
    v_fma_f32 v54, v54, v71, v70
    v_fma_f32 v55, v55, v71, v70
    v_mfma_f32_16x16x32_bf16 a[228:231], a[36:39], v[112:115], a[228:231]
    v_mfma_f32_16x16x32_bf16 a[232:235], a[40:43], v[112:115], a[232:235]
    s_waitcnt vmcnt(5)
    v_max3_f32 v72, |v108|, |v104|, |v100|
    v_mfma_f32_16x16x32_bf16 a[236:239], a[44:47], v[112:115], a[236:239]
    v_cmp_le_f32 vcc, s40, v72
    v_mfma_f32_16x16x32_bf16 v[24:27], a[32:35], v[112:115], v[24:27]
    s_cbranch_vccnz L_hslow31
L_hback31:
    v_mfma_f32_16x16x32_bf16 a[228:231], a[52:55], v[108:111], a[228:231]
    ds_write_b128 v13, a[212:215] offset:2048
    ds_write_b128 v14, a[216:219] offset:2048
    v_mfma_f32_16x16x32_bf16 a[232:235], a[56:59], v[108:111], a[232:235]
    ds_write_b128 v15, a[220:223] offset:2048
    v_mfma_f32_16x16x32_bf16 a[236:239], a[60:63], v[108:111], a[236:239]
    s_waitcnt lgkmcnt(6)
    v_add_f32 v208, v208, v212
    v_add_f32 v76, v76, v216
    v_mfma_f32_16x16x32_bf16 v[24:27], a[48:51], v[108:111], v[24:27]
    v_add_f32 v209, v209, v213
    v_add_f32 v77, v77, v217
    v_mfma_f32_16x16x32_bf16 a[228:231], a[68:71], v[104:107], a[228:231]
    v_add_f32 v210, v210, v214
    v_add_f32 v78, v78, v218
    v_mfma_f32_16x16x32_bf16 a[232:235], a[72:75], v[104:107], a[232:235]
    v_add_f32 v211, v211, v215
    v_add_f32 v79, v79, v219
    v_mfma_f32_16x16x32_bf16 a[236:239], a[76:79], v[104:107], a[236:239]
    v_add_f32 v208, v208, v76
    v_add_f32 v209, v209, v77
    v_mfma_f32_16x16x32_bf16 v[24:27], a[64:67], v[104:107], v[24:27]
    v_add_f32 v210, v210, v78
    v_add_f32 v211, v211, v79
    v_mfma_f32_16x16x32_bf16 a[228:231], a[84:87], v[100:103], a[228:231]
    v_mfma_f32_16x16x32_bf16 a[232:235], a[88:91], v[100:103], a[232:235]
    s_waitcnt vmcnt(2)
    v_max3_f32 v72, |v96|, |v92|, |v88|
    v_mfma_f32_16x16x32_bf16 a[236:239], a[92:95], v[100:103], a[236:239]
    v_cmp_le_f32 vcc, s40, v72
    v_mfma_f32_16x16x32_bf16 v[24:27], a[80:83], v[100:103], v[24:27]
    s_cbranch_vccnz L_hslow32
L_hback32:
    v_mfma_f32_16x16x32_bf16 a[228:231], a[100:103], v[96:99], a[228:231]
    v_fma_f32 v208, v208, s62, v40
    v_fma_f32 v209, v209, s62, v41
    v_mfma_f32_16x16x32_bf16 a[232:235], a[104:107], v[96:99], a[232:235]
    v_fma_f32 v210, v210, s62, v42
    v_fma_f32 v211, v211, s62, v43
    v_mfma_f32_16x16x32_bf16 a[236:239], a[108:111], v[96:99], a[236:239]
    v_cvt_pk_bf16_f32 v200, v208, v209
    v_cvt_pk_bf16_f32 v201, v210, v211
    v_mfma_f32_16x16x32_bf16 v[24:27], a[96:99], v[96:99], v[24:27]
    s_waitcnt lgkmcnt(3)
    v_add_f32 v220, v220, v224
    v_add_f32 v56, v56, v228
    v_mfma_f32_16x16x32_bf16 a[228:231], a[116:119], v[92:95], a[228:231]
    v_add_f32 v221, v221, v225
    v_add_f32 v57, v57, v229
    v_mfma_f32_16x16x32_bf16 a[232:235], a[120:123], v[92:95], a[232:235]
    v_add_f32 v222, v222, v226
    v_add_f32 v58, v58, v230
    v_mfma_f32_16x16x32_bf16 a[236:239], a[124:127], v[92:95], a[236:239]
    v_add_f32 v223, v223, v227
    v_add_f32 v59, v59, v231
    v_mfma_f32_16x16x32_bf16 v[24:27], a[112:115], v[92:95], v[24:27]
    v_add_f32 v220, v220, v56
    v_add_f32 v221, v221, v57
    v_mfma_f32_16x16x32_bf16 a[228:231], a[132:135], v[88:91], a[228:231]
    v_mfma_f32_16x16x32_bf16 a[232:235], a[136:139], v[88:91], a[232:235]
    s_waitcnt vmcnt(0)
    v_max3_f32 v72, |v84|, |v80|, |v80|
    v_mfma_f32_16x16x32_bf16 a[236:239], a[140:143], v[88:91], a[236:239]
    v_cmp_le_f32 vcc, s40, v72
    v_mfma_f32_16x16x32_bf16 v[24:27], a[128:131], v[88:91], v[24:27]
    s_cbranch_vccnz L_hslow33
L_hback33:
    v_mfma_f32_16x16x32_bf16 a[228:231], a[148:151], v[84:87], a[228:231]
    v_add_f32 v222, v222, v58
    v_add_f32 v223, v223, v59
    v_mfma_f32_16x16x32_bf16 a[232:235], a[152:155], v[84:87], a[232:235]
    v_fma_f32 v220, v220, s62, v44
    v_fma_f32 v221, v221, s62, v45
    v_mfma_f32_16x16x32_bf16 a[236:239], a[156:159], v[84:87], a[236:239]
    v_fma_f32 v222, v222, s62, v46
    v_fma_f32 v223, v223, s62, v47
    v_mfma_f32_16x16x32_bf16 v[24:27], a[144:147], v[84:87], v[24:27]
    v_cvt_pk_bf16_f32 v202, v220, v221
    v_cvt_pk_bf16_f32 v203, v222, v223
    v_mfma_f32_16x16x32_bf16 a[228:231], a[164:167], v[80:83], a[228:231]
    v_permlane16_swap_b32 v200, v202
    v_permlane16_swap_b32 v201, v203
    v_mfma_f32_16x16x32_bf16 a[232:235], a[168:171], v[80:83], a[232:235]
    buffer_store_dwordx4 v[200:203], v17, s[28:31], s44 offen
    v_mfma_f32_16x16x32_bf16 a[236:239], a[172:175], v[80:83], a[236:239]
    v_mfma_f32_16x16x32_bf16 v[24:27], a[160:163], v[80:83], v[24:27]
    s_nop 1
    ds_write_b128 v13, a[228:231] offset:3072
    s_nop 1
    ds_write_b128 v14, a[232:235] offset:3072
    s_nop 0
    ds_write_b128 v15, a[236:239] offset:3072
    s_waitcnt lgkmcnt(0)
    s_barrier
    ds_read_b128 v[232:235], v12 offset:2048
    ds_read_b128 v[236:239], v12 offset:6144
    ds_read_b128 v[240:243], v12 offset:10240
    ds_read_b128 v[244:247], v12 offset:3072
    ds_read_b128 v[248:251], v12 offset:7168
    ds_read_b128 v[252:255], v12 offset:11264
    s_waitcnt lgkmcnt(3)
    v_pk_add_f32 v[232:233], v[232:233], v[236:237]
    v_pk_add_f32 v[60:61], v[60:61], v[240:241]
    v_pk_add_f32 v[234:235], v[234:235], v[238:239]
    v_pk_add_f32 v[62:63], v[62:63], v[242:243]
    v_pk_add_f32 v[232:233], v[232:233], v[60:61]
    v_pk_add_f32 v[234:235], v[234:235], v[62:63]
    v_pk_fma_f32 v[232:233], v[232:233], s[62:63], v[48:49]
    v_pk_fma_f32 v[234:235], v[234:235], s[62:63], v[50:51]
    v_cvt_pk_bf16_f32 v204, v232, v233
    v_cvt_pk_bf16_f32 v205, v234, v235
    s_waitcnt lgkmcnt(0)
    v_pk_add_f32 v[244:245], v[244:245], v[248:249]
    v_pk_add_f32 v[24:25], v[24:25], v[252:253]
    v_pk_add_f32 v[246:247], v[246:247], v[250:251]
    v_pk_add_f32 v[26:27], v[26:27], v[254:255]
    v_pk_add_f32 v[244:245], v[244:245], v[24:25]
    v_pk_add_f32 v[246:247], v[246:247], v[26:27]
    v_pk_fma_f32 v[244:245], v[244:245], s[62:63], v[52:53]
    v_pk_fma_f32 v[246:247], v[246:247], s[62:63], v[54:55]
    v_cvt_pk_bf16_f32 v206, v244, v245
    v_cvt_pk_bf16_f32 v207, v246, v247
    s_nop 0
    v_permlane16_swap_b32 v204, v206
    v_permlane16_swap_b32 v205, v207
    buffer_store_dwordx4 v[204:207], v17, s[28:31], s45 offen
L_end:
    s_endpgm
L_h1slow:
    s_mov_b64 exec, vcc
    s_movk_i32 s47, 20000
L_h1:
    buffer_load_dwordx4 v[88:91], v120, s[32:35], s52 offen sc1
    buffer_load_dwordx4 v[92:95], v120, s[32:35], s53 offen sc1
    buffer_load_dwordx4 v[96:99], v120, s[32:35], s54 offen sc1
    buffer_load_dwordx4 v[100:103], v120, s[32:35], s55 offen sc1
    s_waitcnt vmcnt(3)
    v_xor_b32 v88, v127, v88
    v_xor_b32 v89, v128, v89
    v_or_b32 v5, v88, v89
    s_waitcnt vmcnt(2)
    v_xor_b32 v92, v127, v92
    v_xor_b32 v93, v128, v93
    v_or3_b32 v5, v5, v92, v93
    s_waitcnt vmcnt(1)
    v_xor_b32 v96, v127, v96
    v_xor_b32 v97, v128, v97
    v_or3_b32 v5, v5, v96, v97
    s_waitcnt vmcnt(0)
    v_xor_b32 v100, v127, v100
    v_xor_b32 v101, v128, v101
    v_or3_b32 v5, v5, v100, v101
    v_and_b32 v5, s46, v5
    s_nop 1
    v_or_b32_dpp v5, v5, v5 quad_perm:[1,0,3,2] row_mask:0xf bank_mask:0xf
    s_nop 1
    v_or_b32_dpp v5, v5, v5 quad_perm:[2,3,0,1] row_mask:0xf bank_mask:0xf
    v_cmp_ne_u32 vcc, 0, v5
    s_sub_u32 s47, s47, 1
    s_cselect_b64 vcc, 0, vcc
    s_and_b64 exec, exec, vcc
    s_cbranch_execnz L_h1
    s_mov_b64 exec, -1
    s_branch L_h1back
L_h2slow:
    s_mov_b64 exec, vcc
    s_movk_i32 s47, 20000
L_h2:
    buffer_load_dwordx4 v[40:43], v120, s[32:35], s52 offen sc1
    buffer_load_dwordx4 v[44:47], v120, s[32:35], s53 offen sc1
    s_waitcnt vmcnt(1)
    v_xor_b32 v40, v104, v40
    v_xor_b32 v41, v105, v41
    v_xor_b32 v42, v106, v42
    v_xor_b32 v43, v107, v43
    v_or_b32 v5, v40, v41
    v_or3_b32 v5, v5, v42, v43
    s_waitcnt vmcnt(0)
    v_xor_b32 v44, v104, v44
    v_xor_b32 v45, v105, v45
    v_xor_b32 v46, v106, v46
    v_xor_b32 v47, v107, v47
    v_or3_b32 v5, v5, v44, v45
    v_or3_b32 v5, v5, v46, v47
    v_and_b32 v5, s46, v5
    s_nop 1
    v_or_b32_dpp v5, v5, v5 quad_perm:[1,0,3,2] row_mask:0xf bank_mask:0xf
    v_cmp_ne_u32 vcc, 0, v5
    s_sub_u32 s47, s47, 1
    s_cselect_b64 vcc, 0, vcc
    s_and_b64 exec, exec, vcc
    s_cbranch_execnz L_h2
    s_mov_b64 exec, -1
    s_branch L_h2back
L_gslow0:
    s_mov_b32 s38, m0
    s_movk_i32 s47, 20000
L_gspin0:
    s_add_u32 m0, s51, 0
    s_add_u32 s99, s50, 262144
    buffer_load_dwordx4 v22, s[32:35], s99 offen offset:0 sc1 lds
    buffer_load_dwordx4 v29, s[32:35], s99 offen offset:1024 sc1 lds
    buffer_load_dwordx4 v38, s[32:35], s99 offen offset:2048 sc1 lds
    buffer_load_dwordx4 v39, s[32:35], s99 offen offset:3072 sc1 lds
    s_waitcnt vmcnt(0)
    ds_read2st64_b32 v[116:117], v25 offset0:0 offset1:4
    ds_read2st64_b32 v[118:119], v25 offset0:8 offset1:12
    s_waitcnt lgkmcnt(0)
    v_max3_f32 v116, |v116|, |v117|, |v118|
    v_max_f32 v116, v116, |v119|
    v_cmp_le_f32 vcc, s40, v116
    s_sub_u32 s47, s47, 1
    s_cselect_b64 vcc, 0, vcc
    s_cbranch_vccnz L_gspin0
    s_mov_b32 m0, s38
    s_branch L_gback0
L_gslow1:
    s_mov_b32 s38, m0
    s_movk_i32 s47, 20000
L_gspin1:
    s_add_u32 m0, s51, 16384
    s_add_u32 s99, s50, 802816
    buffer_load_dwordx4 v22, s[32:35], s99 offen offset:0 sc1 lds
    buffer_load_dwordx4 v29, s[32:35], s99 offen offset:1024 sc1 lds
    buffer_load_dwordx4 v38, s[32:35], s99 offen offset:2048 sc1 lds
    buffer_load_dwordx4 v39, s[32:35], s99 offen offset:3072 sc1 lds
    s_waitcnt vmcnt(0)
    ds_read2st64_b32 v[116:117], v25 offset0:64 offset1:68
    ds_read2st64_b32 v[118:119], v25 offset0:72 offset1:76
    s_waitcnt lgkmcnt(0)
    v_max3_f32 v116, |v116|, |v117|, |v118|
    v_max_f32 v116, v116, |v119|
    v_cmp_le_f32 vcc, s40, v116
    s_sub_u32 s47, s47, 1
    s_cselect_b64 vcc, 0, vcc
    s_cbranch_vccnz L_gspin1
    s_mov_b32 m0, s38
    s_branch L_gback1
L_gslow2:
    s_mov_b32 s38, m0
    s_movk_i32 s47, 20000
L_gspin2:
    s_add_u32 m0, s51, 32768
    s_add_u32 s99, s50, 1343488
    buffer_load_dwordx4 v22, s[32:35], s99 offen offset:0 sc1 lds
    buffer_load_dwordx4 v29, s[32:35], s99 offen offset:1024 sc1 lds
    buffer_load_dwordx4 v38, s[32:35], s99 offen offset:2048 sc1 lds
    buffer_load_dwordx4 v39, s[32:35], s99 offen offset:3072 sc1 lds
    s_waitcnt vmcnt(0)
    ds_read2st64_b32 v[116:117], v25 offset0:128 offset1:132
    ds_read2st64_b32 v[118:119], v25 offset0:136 offset1:140
    s_waitcnt lgkmcnt(0)
    v_max3_f32 v116, |v116|, |v117|, |v118|
    v_max_f32 v116, v116, |v119|
    v_cmp_le_f32 vcc, s40, v116
    s_sub_u32 s47, s47, 1
    s_cselect_b64 vcc, 0, vcc
    s_cbranch_vccnz L_gspin2
    s_mov_b32 m0, s38
    s_branch L_gback2
L_gslow3:
    s_mov_b32 s38, m0
    s_movk_i32 s47, 20000
L_gspin3:
    s_add_u32 m0, s51, 49152
    s_add_u32 s99, s50, 1884160
    buffer_load_dwordx4 v22, s[32:35], s99 offen offset:0 sc1 lds
    buffer_load_dwordx4 v29, s[32:35], s99 offen offset:1024 sc1 lds
    buffer_load_dwordx4 v38, s[32:35], s99 offen offset:2048 sc1 lds
    buffer_load_dwordx4 v39, s[32:35], s99 offen offset:3072 sc1 lds
    s_waitcnt vmcnt(0)
    ds_read2st64_b32 v[116:117], v25 offset0:192 offset1:196
    ds_read2st64_b32 v[118:119], v25 offset0:200 offset1:204
    s_waitcnt lgkmcnt(0)
    v_max3_f32 v116, |v116|, |v117|, |v118|
    v_max_f32 v116, v116, |v119|
    v_cmp_le_f32 vcc, s40, v116
    s_sub_u32 s47, s47, 1
    s_cselect_b64 vcc, 0, vcc
    s_cbranch_vccnz L_gspin3
    s_mov_b32 m0, s38
    s_branch L_gback3
L_hslow00:
    s_call_b64 s[48:49], L_hre0
    s_branch L_hback00
L_hslow01:
    s_call_b64 s[48:49], L_hre0
    s_branch L_hback01
L_hslow02:
    s_call_b64 s[48:49], L_hre0
    s_branch L_hback02
L_hslow03:
    s_call_b64 s[48:49], L_hre0
    s_branch L_hback03
L_hre0:
    s_movk_i32 s47, 20000
L_hspin0:
    buffer_load_dwordx4 v[252:255], v8, s[32:35], s12 offen sc1
    buffer_load_dwordx4 v[248:251], v8, s[32:35], s13 offen sc1
    buffer_load_dwordx4 v[244:247], v8, s[32:35], s14 offen sc1
    buffer_load_dwordx4 v[240:243], v8, s[32:35], s15 offen sc1
    buffer_load_dwordx4 v[236:239], v8, s[32:35], s16 offen sc1
    buffer_load_dwordx4 v[232:235], v8, s[32:35], s17 offen sc1
    buffer_load_dwordx4 v[228:231], v8, s[32:35], s18 offen sc1
    buffer_load_dwordx4 v[224:227], v8, s[32:35], s19 offen sc1
    buffer_load_dwordx4 v[220:223], v8, s[32:35], s20 offen sc1
    buffer_load_dwordx4 v[216:219], v8, s[32:35], s21 offen sc1
    buffer_load_dwordx4 v[212:215], v8, s[32:35], s22 offen sc1
    s_waitcnt vmcnt(0)
    v_max3_f32 v72, |v252|, |v248|, |v244|
    v_max3_f32 v72, v72, |v240|, |v236|
    v_max3_f32 v72, v72, |v232|, |v228|
    v_max3_f32 v72, v72, |v224|, |v220|
    v_max3_f32 v72, v72, |v216|, |v212|
    v_cmp_le_f32 vcc, s40, v72
    s_sub_u32 s47, s47, 1
    s_cselect_b64 vcc, 0, vcc
    s_cbranch_vccnz L_hspin0
    s_setpc_b64 s[48:49]
L_hslow10:
    s_call_b64 s[48:49], L_hre1
    s_branch L_hback10
L_hslow11:
    s_call_b64 s[48:49], L_hre1
    s_branch L_hback11
L_hslow12:
    s_call_b64 s[48:49], L_hre1
    s_branch L_hback12
L_hslow13:
    s_call_b64 s[48:49], L_hre1
    s_branch L_hback13
L_hre1:
    s_movk_i32 s47, 20000
L_hspin1:
    buffer_load_dwordx4 v[208:211], v9, s[32:35], s12 offen sc1
    buffer_load_dwordx4 v[204:207], v9, s[32:35], s13 offen sc1
    buffer_load_dwordx4 v[200:203], v9, s[32:35], s14 offen sc1
    buffer_load_dwordx4 v[196:199], v9, s[32:35], s15 offen sc1
    buffer_load_dwordx4 v[192:195], v9, s[32:35], s16 offen sc1
    buffer_load_dwordx4 v[188:191], v9, s[32:35], s17 offen sc1
    buffer_load_dwordx4 v[184:187], v9, s[32:35], s18 offen sc1
    buffer_load_dwordx4 v[180:183], v9, s[32:35], s19 offen sc1
    buffer_load_dwordx4 v[176:179], v9, s[32:35], s20 offen sc1
    buffer_load_dwordx4 v[172:175], v9, s[32:35], s21 offen sc1
    buffer_load_dwordx4 v[168:171], v9, s[32:35], s22 offen sc1
    s_waitcnt vmcnt(0)
    v_max3_f32 v72, |v208|, |v204|, |v200|
    v_max3_f32 v72, v72, |v196|, |v192|
    v_max3_f32 v72, v72, |v188|, |v184|
    v_max3_f32 v72, v72, |v180|, |v176|
    v_max3_f32 v72, v72, |v172|, |v168|
    v_cmp_le_f32 vcc, s40, v72
    s_sub_u32 s47, s47, 1
    s_cselect_b64 vcc, 0, vcc
    s_cbranch_vccnz L_hspin1
    s_setpc_b64 s[48:49]
L_hslow20:
    s_call_b64 s[48:49], L_hre2
    s_branch L_hback20
L_hslow21:
    s_call_b64 s[48:49], L_hre2
    s_branch L_hback21
L_hslow22:
    s_call_b64 s[48:49], L_hre2
    s_branch L_hback22
L_hslow23:
    s_call_b64 s[48:49], L_hre2
    s_branch L_hback23
L_hre2:
    s_movk_i32 s47, 20000
L_hspin2:
    buffer_load_dwordx4 v[164:167], v10, s[32:35], s12 offen sc1
    buffer_load_dwordx4 v[160:163], v10, s[32:35], s13 offen sc1
    buffer_load_dwordx4 v[156:159], v10, s[32:35], s14 offen sc1
    buffer_load_dwordx4 v[152:155], v10, s[32:35], s15 offen sc1
    buffer_load_dwordx4 v[148:151], v10, s[32:35], s16 offen sc1
    buffer_load_dwordx4 v[144:147], v10, s[32:35], s17 offen sc1
    buffer_load_dwordx4 v[140:143], v10, s[32:35], s18 offen sc1
    buffer_load_dwordx4 v[136:139], v10, s[32:35], s19 offen sc1
    buffer_load_dwordx4 v[132:135], v10, s[32:35], s20 offen sc1
    buffer_load_dwordx4 v[128:131], v10, s[32:35], s21 offen sc1
    buffer_load_dwordx4 v[124:127], v10, s[32:35], s22 offen sc1
    s_waitcnt vmcnt(0)
    v_max3_f32 v72, |v164|, |v160|, |v156|
    v_max3_f32 v72, v72, |v152|, |v148|
    v_max3_f32 v72, v72, |v144|, |v140|
    v_max3_f32 v72, v72, |v136|, |v132|
    v_max3_f32 v72, v72, |v128|, |v124|
    v_cmp_le_f32 vcc, s40, v72
    s_sub_u32 s47, s47, 1
    s_cselect_b64 vcc, 0, vcc
    s_cbranch_vccnz L_hspin2
    s_setpc_b64 s[48:49]
L_hslow30:
    s_call_b64 s[48:49], L_hre3
    s_branch L_hback30
L_hslow31:
    s_call_b64 s[48:49], L_hre3
    s_branch L_hback31
L_hslow32:
    s_call_b64 s[48:49], L_hre3
    s_branch L_hback32
L_hslow33:
    s_call_b64 s[48:49], L_hre3
    s_branch L_hback33
L_hre3:
    s_movk_i32 s47, 20000
L_hspin3:
    buffer_load_dwordx4 v[120:123], v11, s[32:35], s12 offen sc1
    buffer_load_dwordx4 v[116:119], v11, s[32:35], s13 offen sc1
    buffer_load_dwordx4 v[112:115], v11, s[32:35], s14 offen sc1
    buffer_load_dwordx4 v[108:111], v11, s[32:35], s15 offen sc1
    buffer_load_dwordx4 v[104:107], v11, s[32:35], s16 offen sc1
    buffer_load_dwordx4 v[100:103], v11, s[32:35], s17 offen sc1
    buffer_load_dwordx4 v[96:99], v11, s[32:35], s18 offen sc1
    buffer_load_dwordx4 v[92:95], v11, s[32:35], s19 offen sc1
    buffer_load_dwordx4 v[88:91], v11, s[32:35], s20 offen sc1
    buffer_load_dwordx4 v[84:87], v11, s[32:35], s21 offen sc1
    buffer_load_dwordx4 v[80:83], v11, s[32:35], s22 offen sc1
    s_waitcnt vmcnt(0)
    v_max3_f32 v72, |v120|, |v116|, |v112|
    v_max3_f32 v72, v72, |v108|, |v104|
    v_max3_f32 v72, v72, |v100|, |v96|
    v_max3_f32 v72, v72, |v92|, |v88|
    v_max3_f32 v72, v72, |v84|, |v80|
    v_cmp_le_f32 vcc, s40, v72
    s_sub_u32 s47, s47, 1
    s_cselect_b64 vcc, 0, vcc
    s_cbranch_vccnz L_hspin3
    s_setpc_b64 s[48:49]
L_code_end:
.section .rodata,"a"
.p2align 6
.amdhsa_kernel sequential_preLN__spectral_gfnet__dense_activation_silu__prompt_kernel
  .amdhsa_next_free_vgpr 512
  .amdhsa_next_free_sgpr 102
  .amdhsa_accum_offset 256
  .amdhsa_group_segment_fixed_size 0
  .amdhsa_kernarg_size 72
  .amdhsa_user_sgpr_count 2
  .amdhsa_user_sgpr_kernarg_segment_ptr 1
  .amdhsa_system_sgpr_workgroup_id_x 1
.end_amdhsa_kernel
```
